```python
import torch

def _softmax(x, axis=-1):
    return torch.softmax(x, dim=axis)
def _gelu(x):
    return torch.nn.functional.gelu(x, approximate="tanh")
def _silu(x):
    return torch.nn.functional.silu(x)
def _sigmoid(x):
    return torch.sigmoid(x)
def _layernorm(x, axis=-1, eps=1e-5):
    m = x.mean(dim=axis, keepdim=True)
    v = x.var(dim=axis, keepdim=True, unbiased=False)
    return (x - m) / torch.sqrt(v + eps)
def _scatter_add(tgt, idx, src, axis=0):
    return tgt.clone().index_add_(axis, idx, src)
def _segment_sum(src, seg, n):
    out = torch.zeros((n,) + src.shape[1:], dtype=src.dtype)
    return out.index_add_(0, seg, src)
def _pad(x, pw):
    flat = tuple(v for pair in reversed(pw) for v in pair)
    return torch.nn.functional.pad(x, flat)

kernel_name = 'concat_heads__mha_block_cached__gqa_block_cached__near_ridge'

def setup_inputs():

    _w = (lambda a: (lambda t: t.to(torch.bfloat16) if t.is_floating_point() else t)(torch.as_tensor(a)))
    def _A_setup():
        B, Sq, D = 8, 112, 1024
        H, Sk, Dh = 32, 1024, 128
        return {
            "x": _w((lambda *s: torch.randn(*s, dtype=torch.bfloat16) * 0.8)(B, Sq, D)),
            "k_cache": _w((lambda *s: torch.randn(*s, dtype=torch.bfloat16) * 0.8)(B, H, Sk, Dh)),
            "v_cache": _w((lambda *s: torch.randn(*s, dtype=torch.bfloat16) * 0.05)(B, H, Sk, Dh)),
            "wq": _w((lambda *s: torch.randn(*s, dtype=torch.bfloat16) * 0.8)(D, H * Dh) * (D ** -0.5)),
            "wo": _w((lambda *s: torch.randn(*s, dtype=torch.bfloat16) * 0.05)(H * Dh, D) * ((H * Dh) ** -0.5)),
        }
    _A_in = _A_setup()

    def _B_setup():
        B, Sq, D = 8, 112, 1024
        Hq, Hkv, Sk, Dh = 32, 32, 1024, 128
        assert Hq % Hkv == 0, (Hq, Hkv)
        return {
            "x": _w((lambda *s: torch.randn(*s, dtype=torch.bfloat16) * 0.8)(B, Sq, D)),
            "k_cache": _w((lambda *s: torch.randn(*s, dtype=torch.bfloat16) * 0.8)(B, Hkv, Sk, Dh)),
            "v_cache": _w((lambda *s: torch.randn(*s, dtype=torch.bfloat16) * 0.05)(B, Hkv, Sk, Dh)),
            "wq": _w((lambda *s: torch.randn(*s, dtype=torch.bfloat16) * 0.8)(D, Hq * Dh) * (D ** -0.5)),
            "wo": _w((lambda *s: torch.randn(*s, dtype=torch.bfloat16) * 0.05)(Hq * Dh, D) * ((Hq * Dh) ** -0.5)),
        }
    _B_in = _B_setup()

    return {
        "A_x": _A_in["x"],
        "A_k_cache": _A_in["k_cache"],
        "A_v_cache": _A_in["v_cache"],
        "A_wq": _A_in["wq"],
        "A_wo": _A_in["wo"],
        "B_x": _B_in["x"],
        "B_k_cache": _B_in["k_cache"],
        "B_v_cache": _B_in["v_cache"],
        "B_wq": _B_in["wq"],
        "B_wo": _B_in["wo"],
    }

def reference(A_x, A_k_cache, A_v_cache, A_wq, A_wo, B_x, B_k_cache, B_v_cache, B_wq, B_wo):
    def _A_ref(x, k_cache, v_cache, wq, wo):
        B, Sq, D = x.shape
        H, Dh = 32, 128
        q = (lambda x, *d: x.permute(*d))((x @ wq).reshape(B, Sq, H, Dh), 0, 2, 1, 3)
        scores = torch.einsum("bhqd,bhkd->bhqk", q, k_cache) * (Dh ** -0.5)
        p = _softmax(scores, axis=-1)
        o = torch.einsum("bhqk,bhkd->bhqd", p, v_cache)
        return (lambda x, *d: x.permute(*d))(o, 0, 2, 1, 3).reshape(B, Sq, H * Dh) @ wo

    def _B_ref(x, k_cache, v_cache, wq, wo):
        B, Sq, D = x.shape
        Hq, Dh = 32, 128
        Hkv = k_cache.shape[1]
        rep = Hq // Hkv
        q = (lambda x, *d: x.permute(*d))((x @ wq).reshape(B, Sq, Hq, Dh), 0, 2, 1, 3)
        k = (lambda x, n, axis: torch.repeat_interleave(x, n, dim=axis))(k_cache, rep, axis=1)
        v = (lambda x, n, axis: torch.repeat_interleave(x, n, dim=axis))(v_cache, rep, axis=1)
        scores = torch.einsum("bhqd,bhkd->bhqk", q, k) * (Dh ** -0.5)
        p = _softmax(scores, axis=-1)
        o = torch.einsum("bhqk,bhkd->bhqd", p, v)
        return (lambda x, *d: x.permute(*d))(o, 0, 2, 1, 3).reshape(B, Sq, Hq * Dh) @ wo

    a = _A_ref(A_x, A_k_cache, A_v_cache, A_wq, A_wo)
    b = _B_ref(B_x, B_k_cache, B_v_cache, B_wq, B_wo)
    return torch.concatenate([a, b], axis=-1)
```

```asm
; @launch grid=(256,1,1) block=(512,1,1) lds=163840
.amdgcn_target "amdgcn-amd-amdhsa--gfx950"
.text
.globl concat_heads__mha_block_cached__gqa_block_cached__near_ridge_kernel
.p2align 8
.type concat_heads__mha_block_cached__gqa_block_cached__near_ridge_kernel,@function
concat_heads__mha_block_cached__gqa_block_cached__near_ridge_kernel:
    s_load_dwordx16 s[8:23], s[0:1], 0
    s_load_dwordx8 s[24:31], s[0:1], 64
    s_load_dwordx2 s[32:33], s[0:1], 96
    s_cmp_ge_u32 s2, 256
    s_cbranch_scc1 K_DONE
    v_lshrrev_b32 v2, 6, v0
    v_and_b32 v1, 63, v0
    v_readfirstlane_b32 s3, v2
    s_lshr_b32 s44, s2, 3
    s_bfe_u32 s40, s2, 0x10002
    s_and_b32 s41, s2, 3
    s_and_b32 s42, s44, 7
    s_lshr_b32 s43, s44, 3
    s_lshl2_add_u32 s43, s41, s43
    s_and_b32 s82, s3, 3
    v_lshrrev_b32 v4, 3, v1
    v_and_b32 v5, 7, v1
    v_lshrrev_b32 v6, 4, v1
    v_and_b32 v7, 1, v6
    v_lshlrev_b32 v7, 2, v7
    v_xor_b32 v7, v7, v5
    v_lshlrev_b32 v7, 4, v7
    s_lshl_b32 s76, s82, 5
    s_and_b32 s76, s76, 32
    v_lshl_add_u32 v14, v4, 13, v7
    v_xor_b32 v14, s76, v14
    s_mul_i32 s76, s82, 14
    v_add_u32 v8, s76, v6
    v_and_b32 v8, 7, v8
    v_xor_b32 v8, v8, v5
    v_lshlrev_b32 v8, 4, v8
    v_lshl_add_u32 v15, v4, 11, v8
    v_xor_b32 v11, 64, v15
    s_lshl_b32 s84, s82, 16
    s_lshl_b32 s86, s82, 12
    s_add_u32 s86, s86, 32768
    s_mul_i32 s85, s82, 57344
    s_mul_i32 s87, s82, 3584
    s_add_u32 s87, s87, 114688
    s_mul_i32 s77, s42, 229376
    s_lshl_b32 s92, s43, 9
    s_sub_u32 s62, 8388608, s92
    s_mov_b32 s63, 0x20000
    s_mov_b32 s58, 229376
    s_mov_b32 s59, 0x20000
    v_bfe_u32 v8, v1, 2, 3
    s_lshl_b32 s76, s42, 3
    v_add_u32 v8, s76, v8
    v_lshrrev_b32 v9, 5, v1
    v_lshl_add_u32 v8, v9, 6, v8
    v_lshlrev_b32 v8, 13, v8
    v_and_b32 v10, 3, v1
    v_lshl_add_u32 v8, v10, 7, v8
    v_and_b32 v10, 31, v1
    v_cmp_gt_u32 vcc, 28, v10
    s_and_b32 s76, s43, 3
    s_mul_i32 s76, s76, 28
    v_add_u32 v10, s76, v10
    v_lshlrev_b32 v10, 11, v10
    v_lshl_add_u32 v10, v9, 7, v10
    v_mov_b32 v9, 0x40000000
    v_cndmask_b32 v10, v9, v10, vcc
    s_and_b32 s76, s82, 1
    s_lshl_b32 s35, s76, 20
    s_lshl_b32 s76, s76, 8
    s_mov_b32 s93, 2097152
    s_cmp_ge_u32 s82, 2
    s_cselect_b32 s35, s76, s35
    s_cselect_b32 s93, 512, s93
    s_cselect_b64 vcc, -1, 0
    s_cselect_b32 s70, s58, s62
    s_mov_b32 s71, 0x20000
    v_cndmask_b32 v8, v8, v10, vcc
    s_cmp_eq_u32 s40, 0
    s_waitcnt lgkmcnt(0)
    s_cselect_b64 s[8:9], s[8:9], s[18:19]
    s_cselect_b64 s[14:15], s[14:15], s[24:25]
    s_cselect_b64 s[10:11], s[10:11], s[20:21]
    s_cselect_b64 s[12:13], s[12:13], s[22:23]
    s_cselect_b64 s[16:17], s[16:17], s[26:27]
    s_add_u32 s60, s14, s92
    s_addc_u32 s61, s15, 0
    s_and_b32 s61, s61, 0xffff
    s_add_u32 s56, s8, s77
    s_addc_u32 s57, s9, 0
    s_and_b32 s57, s57, 0xffff
    s_cmp_ge_u32 s82, 2
    s_cselect_b64 s[68:69], s[56:57], s[60:61]
    s_cmp_lt_u32 s3, 4
    s_cbranch_scc1 K_WARM
    buffer_load_dword v244, v8, s[68:71], s35 offen
    s_add_u32 s35, s35, s93
    s_add_u32 m0, s86, 0
    s_nop 0
    buffer_load_dwordx4 v14, s[60:63], s84 offen  lds
    s_add_u32 m0, s86, 896
    s_nop 0
    buffer_load_dwordx4 v14, s[60:63], s84 offen offset:128  lds
    s_add_u32 m0, s86, 1792
    s_nop 0
    buffer_load_dwordx4 v14, s[60:63], s84 offen offset:256  lds
    s_add_u32 m0, s86, 2688
    s_nop 0
    buffer_load_dwordx4 v14, s[60:63], s84 offen offset:384  lds
    s_add_u32 s84, s84, 262144
    s_add_u32 s86, s86, 16384
    s_cmp_ge_u32 s86, 114688
    s_cselect_b32 s92, 81920, 0
    s_sub_u32 s86, s86, s92
    s_mov_b32 s76, s85
    s_add_u32 m0, s87, 0
    s_nop 0
    buffer_load_dwordx4 v15, s[56:59], s76 offen  lds
    s_add_u32 m0, s87, 1024
    s_add_u32 s76, s76, 16384
    buffer_load_dwordx4 v11, s[56:59], s76 offen  lds
    s_add_u32 m0, s87, 2048
    s_add_u32 s76, s76, 16384
    buffer_load_dwordx4 v15, s[56:59], s76 offen  lds
    s_mov_b32 exec_hi, 0
    s_add_u32 m0, s87, 3072
    s_add_u32 s76, s76, 16384
    buffer_load_dwordx4 v11, s[56:59], s76 offen  lds
    s_mov_b32 exec_hi, -1
    s_add_u32 s85, s85, 128
    s_add_u32 s87, s87, 16384
    s_cmp_ge_u32 s87, 163840
    s_cselect_b32 s92, 49152, 0
    s_sub_u32 s87, s87, s92
    s_branch K_COMMON
K_WARM:
    s_getpc_b64 s[94:95]
K_PC:
    s_lshl2_add_u32 s76, s44, s3
    s_lshl_b32 s76, s76, 6
    s_min_u32 s77, s76, K_DONE-K_PC
    s_load_dword s4, s[94:95], s77
    s_add_u32 s76, s76, 8192
    s_min_u32 s77, s76, K_DONE-K_PC
    s_load_dword s5, s[94:95], s77
    s_add_u32 s76, s76, 8192
    s_min_u32 s77, s76, K_DONE-K_PC
    s_load_dword s6, s[94:95], s77
    s_add_u32 s76, s76, 8192
    s_min_u32 s77, s76, K_DONE-K_PC
    s_load_dword s7, s[94:95], s77
    s_add_u32 s76, s76, 8192
    s_min_u32 s77, s76, K_DONE-K_PC
    s_load_dword s4, s[94:95], s77
    s_add_u32 s76, s76, 8192
    s_waitcnt lgkmcnt(0)
K_COMMON:
    s_lshl_b32 s76, s42, 4
    s_add_u32 s76, s76, s43
    s_lshl_b32 s77, s76, 19
    s_add_u32 s48, s10, s77
    s_addc_u32 s49, s11, 0
    s_and_b32 s49, s49, 0xffff
    s_mov_b32 s50, 524288
    s_mov_b32 s51, 0x20000
    s_add_u32 s52, s12, s77
    s_addc_u32 s53, s13, 0
    s_and_b32 s53, s53, 0xffff
    s_mov_b32 s54, 524288
    s_mov_b32 s55, 0x20000
    s_lshl_b32 s77, s40, 2
    s_lshr_b32 s76, s42, 1
    s_add_u32 s77, s77, s76
    s_lshl_b32 s77, s77, 4
    s_add_u32 s77, s77, s43
    s_lshl_b32 s77, s77, 17
    s_add_u32 s64, s32, s77
    s_addc_u32 s65, s33, 0
    s_and_b32 s65, s65, 0xffff
    s_mov_b32 s66, 131072
    s_mov_b32 s67, 0x20000
    s_and_b32 s45, s44, 3
    s_lshr_b32 s46, s44, 2
    s_lshl_b32 s76, s40, 2
    s_add_u32 s76, s76, s45
    s_lshl_b32 s76, s76, 2
    s_add_u32 s76, s76, s41
    s_lshl_b32 s77, s76, 19
    s_add_u32 s36, s32, s77
    s_addc_u32 s37, s33, 0
    s_and_b32 s37, s37, 0xffff
    s_mov_b32 s38, 524288
    s_mov_b32 s39, 0x20000
    s_lshl_b32 s77, s41, 21
    s_lshl_b32 s76, s46, 8
    s_add_u32 s77, s77, s76
    s_sub_u32 s92, 2097152, s76
    s_add_u32 s4, s16, s77
    s_addc_u32 s5, s17, 0
    s_and_b32 s5, s5, 0xffff
    s_mov_b32 s6, s92
    s_mov_b32 s7, 0x20000
    s_mov_b32 s77, 0
    s_add_u32 s96, s30, s77
    s_addc_u32 s97, s31, 0
    s_and_b32 s97, s97, 0xffff
    s_mov_b32 s98, 256
    s_mov_b32 s99, 0x20000
    s_cmp_lt_u32 s3, 4
    s_cbranch_scc1 K_COMP
K_HELP:
    s_and_b32 s77, s82, 1
    s_lshl_b32 s76, s77, 2
    v_add_u32 v9, s76, v6
    v_xor_b32 v9, v9, v5
    v_lshlrev_b32 v9, 4, v9
    v_lshl_add_u32 v2, v4, 8, v9
    v_lshl_add_u32 v3, v4, 8, v7
    v_and_b32 v9, 32, v1
    v_xor_b32 v3, v9, v3
    v_lshl_add_u32 v13, v4, 11, v7
    s_lshl_b32 s76, s77, 5
    v_xor_b32 v13, s76, v13
    v_lshlrev_b32 v10, 4, v1
    s_lshl_b32 s80, s82, 11
    v_add_u32 v12, s80, v10
    s_mov_b32 s81, s80
    s_mov_b32 s74, s80
    s_add_u32 s75, s80, 16384
    s_cmp_lg_u32 s2, 0
    s_cbranch_scc1 NOPUB
    s_cmp_lg_u32 s82, 3
    s_cbranch_scc1 NOPUB
    s_memrealtime s[90:91]
    v_mov_b32 v242, 0
    s_waitcnt lgkmcnt(0)
    s_or_b32 s90, s90, 1
    s_bitset1_b32 s91, 31
    v_mov_b32 v240, s90
    v_mov_b32 v241, s91
    s_mov_b64 exec, 1
    buffer_store_dwordx2 v[240:241], v242, s[96:99], 0 offen sc0 sc1
    s_mov_b64 exec, -1
NOPUB:
    s_add_u32 m0, s86, 0
    s_nop 0
    buffer_load_dwordx4 v14, s[60:63], s84 offen  lds
    s_add_u32 m0, s86, 896
    s_nop 0
    buffer_load_dwordx4 v14, s[60:63], s84 offen offset:128  lds
    s_add_u32 m0, s86, 1792
    s_nop 0
    buffer_load_dwordx4 v14, s[60:63], s84 offen offset:256  lds
    s_add_u32 m0, s86, 2688
    s_nop 0
    buffer_load_dwordx4 v14, s[60:63], s84 offen offset:384  lds
    s_add_u32 s84, s84, 262144
    s_add_u32 s86, s86, 16384
    s_cmp_ge_u32 s86, 114688
    s_cselect_b32 s92, 81920, 0
    s_sub_u32 s86, s86, s92
    s_add_u32 m0, s86, 0
    s_nop 0
    buffer_load_dwordx4 v14, s[60:63], s84 offen  lds
    s_add_u32 m0, s86, 896
    s_nop 0
    buffer_load_dwordx4 v14, s[60:63], s84 offen offset:128  lds
    s_add_u32 m0, s86, 1792
    s_nop 0
    buffer_load_dwordx4 v14, s[60:63], s84 offen offset:256  lds
    s_add_u32 m0, s86, 2688
    s_nop 0
    buffer_load_dwordx4 v14, s[60:63], s84 offen offset:384  lds
    s_add_u32 s84, s84, 262144
    s_add_u32 s86, s86, 16384
    s_cmp_ge_u32 s86, 114688
    s_cselect_b32 s92, 81920, 0
    s_sub_u32 s86, s86, s92
    s_waitcnt vmcnt(8)
    s_barrier
    s_mov_b32 s76, s85
    s_add_u32 m0, s87, 0
    s_nop 0
    buffer_load_dwordx4 v15, s[56:59], s76 offen  lds
    s_add_u32 m0, s87, 1024
    s_add_u32 s76, s76, 16384
    buffer_load_dwordx4 v11, s[56:59], s76 offen  lds
    s_add_u32 m0, s87, 2048
    s_add_u32 s76, s76, 16384
    buffer_load_dwordx4 v15, s[56:59], s76 offen  lds
    s_mov_b32 exec_hi, 0
    s_add_u32 m0, s87, 3072
    s_add_u32 s76, s76, 16384
    buffer_load_dwordx4 v11, s[56:59], s76 offen  lds
    s_mov_b32 exec_hi, -1
    s_add_u32 s85, s85, 128
    s_add_u32 s87, s87, 16384
    s_cmp_ge_u32 s87, 163840
    s_cselect_b32 s92, 49152, 0
    s_sub_u32 s87, s87, s92
    s_add_u32 m0, s86, 0
    s_nop 0
    buffer_load_dwordx4 v14, s[60:63], s84 offen  lds
    s_add_u32 m0, s86, 896
    s_nop 0
    buffer_load_dwordx4 v14, s[60:63], s84 offen offset:128  lds
    s_add_u32 m0, s86, 1792
    s_nop 0
    buffer_load_dwordx4 v14, s[60:63], s84 offen offset:256  lds
    s_add_u32 m0, s86, 2688
    s_nop 0
    buffer_load_dwordx4 v14, s[60:63], s84 offen offset:384  lds
    s_add_u32 s84, s84, 262144
    s_add_u32 s86, s86, 16384
    s_cmp_ge_u32 s86, 114688
    s_cselect_b32 s92, 81920, 0
    s_sub_u32 s86, s86, s92
    s_mov_b32 s76, s85
    s_add_u32 m0, s87, 0
    s_nop 0
    buffer_load_dwordx4 v15, s[56:59], s76 offen  lds
    s_add_u32 m0, s87, 1024
    s_add_u32 s76, s76, 16384
    buffer_load_dwordx4 v11, s[56:59], s76 offen  lds
    s_add_u32 m0, s87, 2048
    s_add_u32 s76, s76, 16384
    buffer_load_dwordx4 v15, s[56:59], s76 offen  lds
    s_mov_b32 exec_hi, 0
    s_add_u32 m0, s87, 3072
    s_add_u32 s76, s76, 16384
    buffer_load_dwordx4 v11, s[56:59], s76 offen  lds
    s_mov_b32 exec_hi, -1
    s_add_u32 s85, s85, 128
    s_add_u32 s87, s87, 16384
    s_cmp_ge_u32 s87, 163840
    s_cselect_b32 s92, 49152, 0
    s_sub_u32 s87, s87, s92
    s_cmp_lg_u32 s45, 0
    s_cbranch_scc1 PS1
    buffer_load_dword v244, v8, s[68:71], s35 offen
    s_add_u32 s35, s35, s93
PS1:
    s_waitcnt vmcnt(16)
    s_barrier
    s_add_u32 m0, s86, 0
    s_nop 0
    buffer_load_dwordx4 v14, s[60:63], s84 offen  lds
    s_add_u32 m0, s86, 896
    s_nop 0
    buffer_load_dwordx4 v14, s[60:63], s84 offen offset:128  lds
    s_add_u32 m0, s86, 1792
    s_nop 0
    buffer_load_dwordx4 v14, s[60:63], s84 offen offset:256  lds
    s_add_u32 m0, s86, 2688
    s_nop 0
    buffer_load_dwordx4 v14, s[60:63], s84 offen offset:384  lds
    s_add_u32 s84, s84, 262144
    s_add_u32 s86, s86, 16384
    s_cmp_ge_u32 s86, 114688
    s_cselect_b32 s92, 81920, 0
    s_sub_u32 s86, s86, s92
    s_add_u32 m0, s86, 0
    s_nop 0
    buffer_load_dwordx4 v14, s[60:63], s84 offen  lds
    s_add_u32 m0, s86, 896
    s_nop 0
    buffer_load_dwordx4 v14, s[60:63], s84 offen offset:128  lds
    s_add_u32 m0, s86, 1792
    s_nop 0
    buffer_load_dwordx4 v14, s[60:63], s84 offen offset:256  lds
    s_add_u32 m0, s86, 2688
    s_nop 0
    buffer_load_dwordx4 v14, s[60:63], s84 offen offset:384  lds
    s_add_u32 s84, s84, 262144
    s_add_u32 s86, s86, 16384
    s_cmp_ge_u32 s86, 114688
    s_cselect_b32 s92, 81920, 0
    s_sub_u32 s86, s86, s92
    s_cmp_lg_u32 s45, 1
    s_cbranch_scc1 PS2
    buffer_load_dword v244, v8, s[68:71], s35 offen
    s_add_u32 s35, s35, s93
PS2:
    s_waitcnt vmcnt(16)
    s_barrier
    s_mov_b32 s76, s85
    s_add_u32 m0, s87, 0
    s_nop 0
    buffer_load_dwordx4 v15, s[56:59], s76 offen  lds
    s_add_u32 m0, s87, 1024
    s_add_u32 s76, s76, 16384
    buffer_load_dwordx4 v11, s[56:59], s76 offen  lds
    s_add_u32 m0, s87, 2048
    s_add_u32 s76, s76, 16384
    buffer_load_dwordx4 v15, s[56:59], s76 offen  lds
    s_mov_b32 exec_hi, 0
    s_add_u32 m0, s87, 3072
    s_add_u32 s76, s76, 16384
    buffer_load_dwordx4 v11, s[56:59], s76 offen  lds
    s_mov_b32 exec_hi, -1
    s_add_u32 s85, s85, 128
    s_add_u32 s87, s87, 16384
    s_cmp_ge_u32 s87, 163840
    s_cselect_b32 s92, 49152, 0
    s_sub_u32 s87, s87, s92
    s_add_u32 m0, s86, 0
    s_nop 0
    buffer_load_dwordx4 v14, s[60:63], s84 offen  lds
    s_add_u32 m0, s86, 896
    s_nop 0
    buffer_load_dwordx4 v14, s[60:63], s84 offen offset:128  lds
    s_add_u32 m0, s86, 1792
    s_nop 0
    buffer_load_dwordx4 v14, s[60:63], s84 offen offset:256  lds
    s_add_u32 m0, s86, 2688
    s_nop 0
    buffer_load_dwordx4 v14, s[60:63], s84 offen offset:384  lds
    s_add_u32 s84, s84, 262144
    s_add_u32 s86, s86, 16384
    s_cmp_ge_u32 s86, 114688
    s_cselect_b32 s92, 81920, 0
    s_sub_u32 s86, s86, s92
    s_cmp_lg_u32 s45, 2
    s_cbranch_scc1 PS3
    buffer_load_dword v244, v8, s[68:71], s35 offen
    s_add_u32 s35, s35, s93
PS3:
    s_waitcnt vmcnt(20)
    s_barrier
    s_add_u32 m0, s86, 0
    s_nop 0
    buffer_load_dwordx4 v14, s[60:63], s84 offen  lds
    s_add_u32 m0, s86, 896
    s_nop 0
    buffer_load_dwordx4 v14, s[60:63], s84 offen offset:128  lds
    s_add_u32 m0, s86, 1792
    s_nop 0
    buffer_load_dwordx4 v14, s[60:63], s84 offen offset:256  lds
    s_add_u32 m0, s86, 2688
    s_nop 0
    buffer_load_dwordx4 v14, s[60:63], s84 offen offset:384  lds
    s_add_u32 s84, s84, 262144
    s_add_u32 s86, s86, 16384
    s_cmp_ge_u32 s86, 114688
    s_cselect_b32 s92, 81920, 0
    s_sub_u32 s86, s86, s92
    s_cmp_lg_u32 s45, 3
    s_cbranch_scc1 PS4
    buffer_load_dword v244, v8, s[68:71], s35 offen
    s_add_u32 s35, s35, s93
PS4:
    s_waitcnt vmcnt(16)
    s_barrier
    s_mov_b32 s76, s85
    s_add_u32 m0, s87, 0
    s_nop 0
    buffer_load_dwordx4 v15, s[56:59], s76 offen  lds
    s_add_u32 m0, s87, 1024
    s_add_u32 s76, s76, 16384
    buffer_load_dwordx4 v11, s[56:59], s76 offen  lds
    s_add_u32 m0, s87, 2048
    s_add_u32 s76, s76, 16384
    buffer_load_dwordx4 v15, s[56:59], s76 offen  lds
    s_mov_b32 exec_hi, 0
    s_add_u32 m0, s87, 3072
    s_add_u32 s76, s76, 16384
    buffer_load_dwordx4 v11, s[56:59], s76 offen  lds
    s_mov_b32 exec_hi, -1
    s_add_u32 s85, s85, 128
    s_add_u32 s87, s87, 16384
    s_cmp_ge_u32 s87, 163840
    s_cselect_b32 s92, 49152, 0
    s_sub_u32 s87, s87, s92
    s_add_u32 m0, s86, 0
    s_nop 0
    buffer_load_dwordx4 v14, s[60:63], s84 offen  lds
    s_add_u32 m0, s86, 896
    s_nop 0
    buffer_load_dwordx4 v14, s[60:63], s84 offen offset:128  lds
    s_add_u32 m0, s86, 1792
    s_nop 0
    buffer_load_dwordx4 v14, s[60:63], s84 offen offset:256  lds
    s_add_u32 m0, s86, 2688
    s_nop 0
    buffer_load_dwordx4 v14, s[60:63], s84 offen offset:384  lds
    s_add_u32 s84, s84, 262144
    s_add_u32 s86, s86, 16384
    s_cmp_ge_u32 s86, 114688
    s_cselect_b32 s92, 81920, 0
    s_sub_u32 s86, s86, s92
    s_add_u32 m0, s74, 0
    s_nop 0
    buffer_load_dwordx4 v2, s[48:51], s80 offen nt lds
    s_add_u32 m0, s74, 896
    s_nop 0
    buffer_load_dwordx4 v2, s[48:51], s80 offen offset:128 nt lds
    s_add_u32 s74, s74, 8192
    s_add_u32 s80, s80, 8192
    s_add_u32 m0, s74, 0
    s_nop 0
    buffer_load_dwordx4 v2, s[48:51], s80 offen nt lds
    s_add_u32 m0, s74, 896
    s_nop 0
    buffer_load_dwordx4 v2, s[48:51], s80 offen offset:128 nt lds
    s_add_u32 s74, s74, 24576
    s_cmp_ge_u32 s74, 163840
    s_cselect_b32 s92, 163840, 0
    s_sub_u32 s74, s74, s92
    s_add_u32 s80, s80, 8192
    s_waitcnt vmcnt(24)
    s_barrier
    s_add_u32 m0, s86, 0
    s_nop 0
    buffer_load_dwordx4 v14, s[60:63], s84 offen  lds
    s_add_u32 m0, s86, 896
    s_nop 0
    buffer_load_dwordx4 v14, s[60:63], s84 offen offset:128  lds
    s_add_u32 m0, s86, 1792
    s_nop 0
    buffer_load_dwordx4 v14, s[60:63], s84 offen offset:256  lds
    s_add_u32 m0, s86, 2688
    s_nop 0
    buffer_load_dwordx4 v14, s[60:63], s84 offen offset:384  lds
    s_add_u32 s84, s84, 262144
    s_add_u32 s86, s86, 16384
    s_cmp_ge_u32 s86, 114688
    s_cselect_b32 s92, 81920, 0
    s_sub_u32 s86, s86, s92
    s_waitcnt vmcnt(20)
    s_barrier
    s_mov_b32 s76, s85
    s_add_u32 m0, s87, 0
    s_nop 0
    buffer_load_dwordx4 v15, s[56:59], s76 offen  lds
    s_add_u32 m0, s87, 1024
    s_add_u32 s76, s76, 16384
    buffer_load_dwordx4 v11, s[56:59], s76 offen  lds
    s_add_u32 m0, s87, 2048
    s_add_u32 s76, s76, 16384
    buffer_load_dwordx4 v15, s[56:59], s76 offen  lds
    s_mov_b32 exec_hi, 0
    s_add_u32 m0, s87, 3072
    s_add_u32 s76, s76, 16384
    buffer_load_dwordx4 v11, s[56:59], s76 offen  lds
    s_mov_b32 exec_hi, -1
    s_add_u32 s85, s85, 128
    s_add_u32 s87, s87, 16384
    s_cmp_ge_u32 s87, 163840
    s_cselect_b32 s92, 49152, 0
    s_sub_u32 s87, s87, s92
    s_add_u32 m0, s86, 0
    s_nop 0
    buffer_load_dwordx4 v14, s[60:63], s84 offen  lds
    s_add_u32 m0, s86, 896
    s_nop 0
    buffer_load_dwordx4 v14, s[60:63], s84 offen offset:128  lds
    s_add_u32 m0, s86, 1792
    s_nop 0
    buffer_load_dwordx4 v14, s[60:63], s84 offen offset:256  lds
    s_add_u32 m0, s86, 2688
    s_nop 0
    buffer_load_dwordx4 v14, s[60:63], s84 offen offset:384  lds
    s_add_u32 s84, s84, 262144
    s_add_u32 s86, s86, 16384
    s_cmp_ge_u32 s86, 114688
    s_cselect_b32 s92, 81920, 0
    s_sub_u32 s86, s86, s92
    s_cmp_lg_u32 s45, 0
    s_cbranch_scc1 PS5
    buffer_load_dword v244, v8, s[68:71], s35 offen
    s_add_u32 s35, s35, s93
PS5:
    s_waitcnt vmcnt(24)
    s_barrier
    s_add_u32 m0, s86, 0
    s_nop 0
    buffer_load_dwordx4 v14, s[60:63], s84 offen  lds
    s_add_u32 m0, s86, 896
    s_nop 0
    buffer_load_dwordx4 v14, s[60:63], s84 offen offset:128  lds
    s_add_u32 m0, s86, 1792
    s_nop 0
    buffer_load_dwordx4 v14, s[60:63], s84 offen offset:256  lds
    s_add_u32 m0, s86, 2688
    s_nop 0
    buffer_load_dwordx4 v14, s[60:63], s84 offen offset:384  lds
    s_add_u32 s84, s84, 262144
    s_add_u32 s86, s86, 16384
    s_cmp_ge_u32 s86, 114688
    s_cselect_b32 s92, 81920, 0
    s_sub_u32 s86, s86, s92
    s_add_u32 m0, s75, 0
    s_nop 0
    buffer_load_dwordx4 v3, s[52:55], s81 offen nt lds
    s_add_u32 m0, s75, 896
    s_nop 0
    buffer_load_dwordx4 v3, s[52:55], s81 offen offset:128 nt lds
    s_add_u32 s75, s75, 8192
    s_add_u32 s81, s81, 8192
    s_add_u32 m0, s75, 0
    s_nop 0
    buffer_load_dwordx4 v3, s[52:55], s81 offen nt lds
    s_add_u32 m0, s75, 896
    s_nop 0
    buffer_load_dwordx4 v3, s[52:55], s81 offen offset:128 nt lds
    s_add_u32 s75, s75, 24576
    s_cmp_ge_u32 s75, 163840
    s_cselect_b32 s92, 163840, 0
    s_sub_u32 s75, s75, s92
    s_add_u32 s81, s81, 8192
    s_waitcnt vmcnt(24)
    s_barrier
    s_mov_b32 s76, s85
    s_add_u32 m0, s87, 0
    s_nop 0
    buffer_load_dwordx4 v15, s[56:59], s76 offen  lds
    s_add_u32 m0, s87, 1024
    s_add_u32 s76, s76, 16384
    buffer_load_dwordx4 v11, s[56:59], s76 offen  lds
    s_add_u32 m0, s87, 2048
    s_add_u32 s76, s76, 16384
    buffer_load_dwordx4 v15, s[56:59], s76 offen  lds
    s_mov_b32 exec_hi, 0
    s_add_u32 m0, s87, 3072
    s_add_u32 s76, s76, 16384
    buffer_load_dwordx4 v11, s[56:59], s76 offen  lds
    s_mov_b32 exec_hi, -1
    s_add_u32 s85, s85, 128
    s_add_u32 s87, s87, 16384
    s_cmp_ge_u32 s87, 163840
    s_cselect_b32 s92, 49152, 0
    s_sub_u32 s87, s87, s92
    s_add_u32 m0, s86, 0
    s_nop 0
    buffer_load_dwordx4 v14, s[60:63], s84 offen  lds
    s_add_u32 m0, s86, 896
    s_nop 0
    buffer_load_dwordx4 v14, s[60:63], s84 offen offset:128  lds
    s_add_u32 m0, s86, 1792
    s_nop 0
    buffer_load_dwordx4 v14, s[60:63], s84 offen offset:256  lds
    s_add_u32 m0, s86, 2688
    s_nop 0
    buffer_load_dwordx4 v14, s[60:63], s84 offen offset:384  lds
    s_add_u32 s84, s84, 262144
    s_add_u32 s86, s86, 16384
    s_cmp_ge_u32 s86, 114688
    s_cselect_b32 s92, 81920, 0
    s_sub_u32 s86, s86, s92
    s_cmp_lg_u32 s45, 1
    s_cbranch_scc1 PS6
    buffer_load_dword v244, v8, s[68:71], s35 offen
    s_add_u32 s35, s35, s93
PS6:
    s_waitcnt vmcnt(24)
    s_barrier
    s_add_u32 m0, s86, 0
    s_nop 0
    buffer_load_dwordx4 v14, s[60:63], s84 offen  lds
    s_add_u32 m0, s86, 896
    s_nop 0
    buffer_load_dwordx4 v14, s[60:63], s84 offen offset:128  lds
    s_add_u32 m0, s86, 1792
    s_nop 0
    buffer_load_dwordx4 v14, s[60:63], s84 offen offset:256  lds
    s_add_u32 m0, s86, 2688
    s_nop 0
    buffer_load_dwordx4 v14, s[60:63], s84 offen offset:384  lds
    s_add_u32 s84, s84, 262144
    s_add_u32 s86, s86, 16384
    s_cmp_ge_u32 s86, 114688
    s_cselect_b32 s92, 81920, 0
    s_sub_u32 s86, s86, s92
    s_waitcnt vmcnt(20)
    s_barrier
    s_mov_b32 s76, s85
    s_add_u32 m0, s87, 0
    s_nop 0
    buffer_load_dwordx4 v15, s[56:59], s76 offen  lds
    s_add_u32 m0, s87, 1024
    s_add_u32 s76, s76, 16384
    buffer_load_dwordx4 v11, s[56:59], s76 offen  lds
    s_add_u32 m0, s87, 2048
    s_add_u32 s76, s76, 16384
    buffer_load_dwordx4 v15, s[56:59], s76 offen  lds
    s_mov_b32 exec_hi, 0
    s_add_u32 m0, s87, 3072
    s_add_u32 s76, s76, 16384
    buffer_load_dwordx4 v11, s[56:59], s76 offen  lds
    s_mov_b32 exec_hi, -1
    s_add_u32 s85, s85, 128
    s_add_u32 s87, s87, 16384
    s_cmp_ge_u32 s87, 163840
    s_cselect_b32 s92, 49152, 0
    s_sub_u32 s87, s87, s92
    s_add_u32 m0, s86, 0
    s_nop 0
    buffer_load_dwordx4 v14, s[60:63], s84 offen  lds
    s_add_u32 m0, s86, 896
    s_nop 0
    buffer_load_dwordx4 v14, s[60:63], s84 offen offset:128  lds
    s_add_u32 m0, s86, 1792
    s_nop 0
    buffer_load_dwordx4 v14, s[60:63], s84 offen offset:256  lds
    s_add_u32 m0, s86, 2688
    s_nop 0
    buffer_load_dwordx4 v14, s[60:63], s84 offen offset:384  lds
    s_add_u32 s84, s84, 262144
    s_add_u32 s86, s86, 16384
    s_cmp_ge_u32 s86, 114688
    s_cselect_b32 s92, 81920, 0
    s_sub_u32 s86, s86, s92
    s_cmp_lg_u32 s45, 2
    s_cbranch_scc1 PS7
    buffer_load_dword v244, v8, s[68:71], s35 offen
    s_add_u32 s35, s35, s93
PS7:
    s_waitcnt vmcnt(24)
    s_barrier
    s_add_u32 m0, s86, 0
    s_nop 0
    buffer_load_dwordx4 v14, s[60:63], s84 offen  lds
    s_add_u32 m0, s86, 896
    s_nop 0
    buffer_load_dwordx4 v14, s[60:63], s84 offen offset:128  lds
    s_add_u32 m0, s86, 1792
    s_nop 0
    buffer_load_dwordx4 v14, s[60:63], s84 offen offset:256  lds
    s_add_u32 m0, s86, 2688
    s_nop 0
    buffer_load_dwordx4 v14, s[60:63], s84 offen offset:384  lds
    s_add_u32 s84, s84, 262144
    s_add_u32 s86, s86, 16384
    s_cmp_ge_u32 s86, 114688
    s_cselect_b32 s92, 81920, 0
    s_sub_u32 s86, s86, s92
    buffer_load_dwordx4 v[16:19], v2, s[48:51], s80 offen nt
    buffer_load_dwordx4 v[20:23], v2, s[48:51], s80 offen offset:128 nt
    s_add_u32 s74, s74, 8192
    s_add_u32 s80, s80, 8192
    buffer_load_dwordx4 v[24:27], v2, s[48:51], s80 offen nt
    buffer_load_dwordx4 v[28:31], v2, s[48:51], s80 offen offset:128 nt
    s_add_u32 s74, s74, 24576
    s_cmp_ge_u32 s74, 163840
    s_cselect_b32 s92, 163840, 0
    s_sub_u32 s74, s74, s92
    s_add_u32 s80, s80, 8192
    s_waitcnt vmcnt(20)
    s_barrier
    s_mov_b32 s76, s85
    s_add_u32 m0, s87, 0
    s_nop 0
    buffer_load_dwordx4 v15, s[56:59], s76 offen  lds
    s_add_u32 m0, s87, 1024
    s_add_u32 s76, s76, 16384
    buffer_load_dwordx4 v11, s[56:59], s76 offen  lds
    s_add_u32 m0, s87, 2048
    s_add_u32 s76, s76, 16384
    buffer_load_dwordx4 v15, s[56:59], s76 offen  lds
    s_mov_b32 exec_hi, 0
    s_add_u32 m0, s87, 3072
    s_add_u32 s76, s76, 16384
    buffer_load_dwordx4 v11, s[56:59], s76 offen  lds
    s_mov_b32 exec_hi, -1
    s_add_u32 s85, s85, 128
    s_add_u32 s87, s87, 16384
    s_cmp_ge_u32 s87, 163840
    s_cselect_b32 s92, 49152, 0
    s_sub_u32 s87, s87, s92
    s_add_u32 m0, s86, 0
    s_nop 0
    buffer_load_dwordx4 v14, s[60:63], s84 offen  lds
    s_add_u32 m0, s86, 896
    s_nop 0
    buffer_load_dwordx4 v14, s[60:63], s84 offen offset:128  lds
    s_add_u32 m0, s86, 1792
    s_nop 0
    buffer_load_dwordx4 v14, s[60:63], s84 offen offset:256  lds
    s_add_u32 m0, s86, 2688
    s_nop 0
    buffer_load_dwordx4 v14, s[60:63], s84 offen offset:384  lds
    s_add_u32 s84, s84, 262144
    s_add_u32 s86, s86, 16384
    s_cmp_ge_u32 s86, 114688
    s_cselect_b32 s92, 81920, 0
    s_sub_u32 s86, s86, s92
    s_cmp_lg_u32 s45, 3
    s_cbranch_scc1 PS8
    buffer_load_dword v244, v8, s[68:71], s35 offen
    s_add_u32 s35, s35, s93
PS8:
    s_waitcnt vmcnt(24)
    s_barrier
    s_add_u32 m0, s86, 0
    s_nop 0
    buffer_load_dwordx4 v14, s[60:63], s84 offen  lds
    s_add_u32 m0, s86, 896
    s_nop 0
    buffer_load_dwordx4 v14, s[60:63], s84 offen offset:128  lds
    s_add_u32 m0, s86, 1792
    s_nop 0
    buffer_load_dwordx4 v14, s[60:63], s84 offen offset:256  lds
    s_add_u32 m0, s86, 2688
    s_nop 0
    buffer_load_dwordx4 v14, s[60:63], s84 offen offset:384  lds
    s_add_u32 s84, s84, 262144
    s_add_u32 s86, s86, 16384
    s_cmp_ge_u32 s86, 114688
    s_cselect_b32 s92, 81920, 0
    s_sub_u32 s86, s86, s92
    s_waitcnt vmcnt(20)
    s_barrier
    s_mov_b32 s76, s85
    s_add_u32 m0, s87, 0
    s_nop 0
    buffer_load_dwordx4 v15, s[56:59], s76 offen  lds
    s_add_u32 m0, s87, 1024
    s_add_u32 s76, s76, 16384
    buffer_load_dwordx4 v11, s[56:59], s76 offen  lds
    s_add_u32 m0, s87, 2048
    s_add_u32 s76, s76, 16384
    buffer_load_dwordx4 v15, s[56:59], s76 offen  lds
    s_mov_b32 exec_hi, 0
    s_add_u32 m0, s87, 3072
    s_add_u32 s76, s76, 16384
    buffer_load_dwordx4 v11, s[56:59], s76 offen  lds
    s_mov_b32 exec_hi, -1
    s_add_u32 s85, s85, 128
    s_add_u32 s87, s87, 16384
    s_cmp_ge_u32 s87, 163840
    s_cselect_b32 s92, 49152, 0
    s_sub_u32 s87, s87, s92
    s_add_u32 m0, s86, 0
    s_nop 0
    buffer_load_dwordx4 v14, s[60:63], s84 offen  lds
    s_add_u32 m0, s86, 896
    s_nop 0
    buffer_load_dwordx4 v14, s[60:63], s84 offen offset:128  lds
    s_add_u32 m0, s86, 1792
    s_nop 0
    buffer_load_dwordx4 v14, s[60:63], s84 offen offset:256  lds
    s_add_u32 m0, s86, 2688
    s_nop 0
    buffer_load_dwordx4 v14, s[60:63], s84 offen offset:384  lds
    s_add_u32 s84, s84, 262144
    s_add_u32 s86, s86, 16384
    s_cmp_ge_u32 s86, 114688
    s_cselect_b32 s92, 81920, 0
    s_sub_u32 s86, s86, s92
    s_cmp_lg_u32 s45, 0
    s_cbranch_scc1 PS9
    buffer_load_dword v244, v8, s[68:71], s35 offen
    s_add_u32 s35, s35, s93
PS9:
    s_waitcnt vmcnt(24)
    s_barrier
    s_add_u32 m0, s86, 0
    s_nop 0
    buffer_load_dwordx4 v14, s[60:63], s84 offen  lds
    s_add_u32 m0, s86, 896
    s_nop 0
    buffer_load_dwordx4 v14, s[60:63], s84 offen offset:128  lds
    s_add_u32 m0, s86, 1792
    s_nop 0
    buffer_load_dwordx4 v14, s[60:63], s84 offen offset:256  lds
    s_add_u32 m0, s86, 2688
    s_nop 0
    buffer_load_dwordx4 v14, s[60:63], s84 offen offset:384  lds
    s_add_u32 s84, s84, 262144
    s_add_u32 s86, s86, 16384
    s_cmp_ge_u32 s86, 114688
    s_cselect_b32 s92, 81920, 0
    s_sub_u32 s86, s86, s92
    buffer_load_dwordx4 v[32:35], v3, s[52:55], s81 offen nt
    buffer_load_dwordx4 v[36:39], v3, s[52:55], s81 offen offset:128 nt
    s_add_u32 s75, s75, 8192
    s_add_u32 s81, s81, 8192
    buffer_load_dwordx4 v[40:43], v3, s[52:55], s81 offen nt
    buffer_load_dwordx4 v[44:47], v3, s[52:55], s81 offen offset:128 nt
    s_add_u32 s75, s75, 24576
    s_cmp_ge_u32 s75, 163840
    s_cselect_b32 s92, 163840, 0
    s_sub_u32 s75, s75, s92
    s_add_u32 s81, s81, 8192
    s_waitcnt vmcnt(20)
    s_barrier
    s_mov_b32 s76, s85
    s_add_u32 m0, s87, 0
    s_nop 0
    buffer_load_dwordx4 v15, s[56:59], s76 offen  lds
    s_add_u32 m0, s87, 1024
    s_add_u32 s76, s76, 16384
    buffer_load_dwordx4 v11, s[56:59], s76 offen  lds
    s_add_u32 m0, s87, 2048
    s_add_u32 s76, s76, 16384
    buffer_load_dwordx4 v15, s[56:59], s76 offen  lds
    s_mov_b32 exec_hi, 0
    s_add_u32 m0, s87, 3072
    s_add_u32 s76, s76, 16384
    buffer_load_dwordx4 v11, s[56:59], s76 offen  lds
    s_mov_b32 exec_hi, -1
    s_add_u32 s85, s85, 128
    s_add_u32 s87, s87, 16384
    s_cmp_ge_u32 s87, 163840
    s_cselect_b32 s92, 49152, 0
    s_sub_u32 s87, s87, s92
    s_add_u32 m0, s86, 0
    s_nop 0
    buffer_load_dwordx4 v14, s[60:63], s84 offen  lds
    s_add_u32 m0, s86, 896
    s_nop 0
    buffer_load_dwordx4 v14, s[60:63], s84 offen offset:128  lds
    s_add_u32 m0, s86, 1792
    s_nop 0
    buffer_load_dwordx4 v14, s[60:63], s84 offen offset:256  lds
    s_add_u32 m0, s86, 2688
    s_nop 0
    buffer_load_dwordx4 v14, s[60:63], s84 offen offset:384  lds
    s_add_u32 s84, s84, 262144
    s_add_u32 s86, s86, 16384
    s_cmp_ge_u32 s86, 114688
    s_cselect_b32 s92, 81920, 0
    s_sub_u32 s86, s86, s92
    s_cmp_lg_u32 s45, 1
    s_cbranch_scc1 PS10
    buffer_load_dword v244, v8, s[68:71], s35 offen
    s_add_u32 s35, s35, s93
PS10:
    s_waitcnt vmcnt(24)
    s_barrier
    s_add_u32 m0, s86, 0
    s_nop 0
    buffer_load_dwordx4 v14, s[60:63], s84 offen  lds
    s_add_u32 m0, s86, 896
    s_nop 0
    buffer_load_dwordx4 v14, s[60:63], s84 offen offset:128  lds
    s_add_u32 m0, s86, 1792
    s_nop 0
    buffer_load_dwordx4 v14, s[60:63], s84 offen offset:256  lds
    s_add_u32 m0, s86, 2688
    s_nop 0
    buffer_load_dwordx4 v14, s[60:63], s84 offen offset:384  lds
    s_add_u32 s84, s84, 262144
    s_add_u32 s86, s86, 16384
    s_cmp_ge_u32 s86, 114688
    s_cselect_b32 s92, 81920, 0
    s_sub_u32 s86, s86, s92
    s_waitcnt vmcnt(20)
    s_barrier
    s_mov_b32 s76, s85
    s_add_u32 m0, s87, 0
    s_nop 0
    buffer_load_dwordx4 v15, s[56:59], s76 offen  lds
    s_add_u32 m0, s87, 1024
    s_add_u32 s76, s76, 16384
    buffer_load_dwordx4 v11, s[56:59], s76 offen  lds
    s_add_u32 m0, s87, 2048
    s_add_u32 s76, s76, 16384
    buffer_load_dwordx4 v15, s[56:59], s76 offen  lds
    s_mov_b32 exec_hi, 0
    s_add_u32 m0, s87, 3072
    s_add_u32 s76, s76, 16384
    buffer_load_dwordx4 v11, s[56:59], s76 offen  lds
    s_mov_b32 exec_hi, -1
    s_add_u32 s85, s85, 128
    s_add_u32 s87, s87, 16384
    s_cmp_ge_u32 s87, 163840
    s_cselect_b32 s92, 49152, 0
    s_sub_u32 s87, s87, s92
    s_add_u32 m0, s86, 0
    s_nop 0
    buffer_load_dwordx4 v14, s[60:63], s84 offen  lds
    s_add_u32 m0, s86, 896
    s_nop 0
    buffer_load_dwordx4 v14, s[60:63], s84 offen offset:128  lds
    s_add_u32 m0, s86, 1792
    s_nop 0
    buffer_load_dwordx4 v14, s[60:63], s84 offen offset:256  lds
    s_add_u32 m0, s86, 2688
    s_nop 0
    buffer_load_dwordx4 v14, s[60:63], s84 offen offset:384  lds
    s_add_u32 s84, s84, 262144
    s_add_u32 s86, s86, 16384
    s_cmp_ge_u32 s86, 114688
    s_cselect_b32 s92, 81920, 0
    s_sub_u32 s86, s86, s92
    s_cmp_lg_u32 s45, 2
    s_cbranch_scc1 PS11
    buffer_load_dword v244, v8, s[68:71], s35 offen
    s_add_u32 s35, s35, s93
PS11:
    s_waitcnt vmcnt(24)
    s_barrier
    s_add_u32 m0, s86, 0
    s_nop 0
    buffer_load_dwordx4 v14, s[60:63], s84 offen  lds
    s_add_u32 m0, s86, 896
    s_nop 0
    buffer_load_dwordx4 v14, s[60:63], s84 offen offset:128  lds
    s_add_u32 m0, s86, 1792
    s_nop 0
    buffer_load_dwordx4 v14, s[60:63], s84 offen offset:256  lds
    s_add_u32 m0, s86, 2688
    s_nop 0
    buffer_load_dwordx4 v14, s[60:63], s84 offen offset:384  lds
    s_add_u32 s84, s84, 262144
    s_add_u32 s86, s86, 16384
    s_cmp_ge_u32 s86, 114688
    s_cselect_b32 s92, 81920, 0
    s_sub_u32 s86, s86, s92
    buffer_load_dwordx4 v[48:51], v2, s[48:51], s80 offen nt
    buffer_load_dwordx4 v[52:55], v2, s[48:51], s80 offen offset:128 nt
    s_add_u32 s74, s74, 8192
    s_add_u32 s80, s80, 8192
    buffer_load_dwordx4 v[56:59], v2, s[48:51], s80 offen nt
    buffer_load_dwordx4 v[60:63], v2, s[48:51], s80 offen offset:128 nt
    s_add_u32 s74, s74, 24576
    s_cmp_ge_u32 s74, 163840
    s_cselect_b32 s92, 163840, 0
    s_sub_u32 s74, s74, s92
    s_add_u32 s80, s80, 8192
    s_waitcnt vmcnt(20)
    s_barrier
    s_mov_b32 s76, s85
    s_add_u32 m0, s87, 0
    s_nop 0
    buffer_load_dwordx4 v15, s[56:59], s76 offen  lds
    s_add_u32 m0, s87, 1024
    s_add_u32 s76, s76, 16384
    buffer_load_dwordx4 v11, s[56:59], s76 offen  lds
    s_add_u32 m0, s87, 2048
    s_add_u32 s76, s76, 16384
    buffer_load_dwordx4 v15, s[56:59], s76 offen  lds
    s_mov_b32 exec_hi, 0
    s_add_u32 m0, s87, 3072
    s_add_u32 s76, s76, 16384
    buffer_load_dwordx4 v11, s[56:59], s76 offen  lds
    s_mov_b32 exec_hi, -1
    s_add_u32 s85, s85, 128
    s_add_u32 s87, s87, 16384
    s_cmp_ge_u32 s87, 163840
    s_cselect_b32 s92, 49152, 0
    s_sub_u32 s87, s87, s92
    s_add_u32 m0, s86, 0
    s_nop 0
    buffer_load_dwordx4 v14, s[60:63], s84 offen  lds
    s_add_u32 m0, s86, 896
    s_nop 0
    buffer_load_dwordx4 v14, s[60:63], s84 offen offset:128  lds
    s_add_u32 m0, s86, 1792
    s_nop 0
    buffer_load_dwordx4 v14, s[60:63], s84 offen offset:256  lds
    s_add_u32 m0, s86, 2688
    s_nop 0
    buffer_load_dwordx4 v14, s[60:63], s84 offen offset:384  lds
    s_add_u32 s84, s84, 262144
    s_add_u32 s86, s86, 16384
    s_cmp_ge_u32 s86, 114688
    s_cselect_b32 s92, 81920, 0
    s_sub_u32 s86, s86, s92
    s_cmp_lg_u32 s45, 3
    s_cbranch_scc1 PS12
    buffer_load_dword v244, v8, s[68:71], s35 offen
    s_add_u32 s35, s35, s93
PS12:
    s_waitcnt vmcnt(24)
    s_barrier
    s_add_u32 m0, s86, 0
    s_nop 0
    buffer_load_dwordx4 v14, s[60:63], s84 offen  lds
    s_add_u32 m0, s86, 896
    s_nop 0
    buffer_load_dwordx4 v14, s[60:63], s84 offen offset:128  lds
    s_add_u32 m0, s86, 1792
    s_nop 0
    buffer_load_dwordx4 v14, s[60:63], s84 offen offset:256  lds
    s_add_u32 m0, s86, 2688
    s_nop 0
    buffer_load_dwordx4 v14, s[60:63], s84 offen offset:384  lds
    s_add_u32 s84, s84, 262144
    s_add_u32 s86, s86, 16384
    s_cmp_ge_u32 s86, 114688
    s_cselect_b32 s92, 81920, 0
    s_sub_u32 s86, s86, s92
    s_waitcnt vmcnt(20)
    s_barrier
    s_mov_b32 s76, s85
    s_add_u32 m0, s87, 0
    s_nop 0
    buffer_load_dwordx4 v15, s[56:59], s76 offen  lds
    s_add_u32 m0, s87, 1024
    s_add_u32 s76, s76, 16384
    buffer_load_dwordx4 v11, s[56:59], s76 offen  lds
    s_add_u32 m0, s87, 2048
    s_add_u32 s76, s76, 16384
    buffer_load_dwordx4 v15, s[56:59], s76 offen  lds
    s_mov_b32 exec_hi, 0
    s_add_u32 m0, s87, 3072
    s_add_u32 s76, s76, 16384
    buffer_load_dwordx4 v11, s[56:59], s76 offen  lds
    s_mov_b32 exec_hi, -1
    s_add_u32 s85, s85, 128
    s_add_u32 s87, s87, 16384
    s_cmp_ge_u32 s87, 163840
    s_cselect_b32 s92, 49152, 0
    s_sub_u32 s87, s87, s92
    s_add_u32 m0, s86, 0
    s_nop 0
    buffer_load_dwordx4 v14, s[60:63], s84 offen  lds
    s_add_u32 m0, s86, 896
    s_nop 0
    buffer_load_dwordx4 v14, s[60:63], s84 offen offset:128  lds
    s_add_u32 m0, s86, 1792
    s_nop 0
    buffer_load_dwordx4 v14, s[60:63], s84 offen offset:256  lds
    s_add_u32 m0, s86, 2688
    s_nop 0
    buffer_load_dwordx4 v14, s[60:63], s84 offen offset:384  lds
    s_add_u32 s84, s84, 262144
    s_add_u32 s86, s86, 16384
    s_cmp_ge_u32 s86, 114688
    s_cselect_b32 s92, 81920, 0
    s_sub_u32 s86, s86, s92
    buffer_load_dwordx4 v[64:67], v3, s[52:55], s81 offen nt
    buffer_load_dwordx4 v[68:71], v3, s[52:55], s81 offen offset:128 nt
    s_add_u32 s75, s75, 8192
    s_add_u32 s81, s81, 8192
    buffer_load_dwordx4 v[72:75], v3, s[52:55], s81 offen nt
    buffer_load_dwordx4 v[76:79], v3, s[52:55], s81 offen offset:128 nt
    s_add_u32 s75, s75, 24576
    s_cmp_ge_u32 s75, 163840
    s_cselect_b32 s92, 163840, 0
    s_sub_u32 s75, s75, s92
    s_add_u32 s81, s81, 8192
    s_waitcnt vmcnt(28)
    s_barrier
    s_add_u32 m0, s86, 0
    s_nop 0
    buffer_load_dwordx4 v14, s[60:63], s84 offen  lds
    s_add_u32 m0, s86, 896
    s_nop 0
    buffer_load_dwordx4 v14, s[60:63], s84 offen offset:128  lds
    s_add_u32 m0, s86, 1792
    s_nop 0
    buffer_load_dwordx4 v14, s[60:63], s84 offen offset:256  lds
    s_add_u32 m0, s86, 2688
    s_nop 0
    buffer_load_dwordx4 v14, s[60:63], s84 offen offset:384  lds
    s_add_u32 s84, s84, 262144
    s_add_u32 s86, s86, 16384
    s_cmp_ge_u32 s86, 114688
    s_cselect_b32 s92, 81920, 0
    s_sub_u32 s86, s86, s92
    s_waitcnt vmcnt(20)
    s_barrier
    s_mov_b32 s76, s85
    s_add_u32 m0, s87, 0
    s_nop 0
    buffer_load_dwordx4 v15, s[56:59], s76 offen  lds
    s_add_u32 m0, s87, 1024
    s_add_u32 s76, s76, 16384
    buffer_load_dwordx4 v11, s[56:59], s76 offen  lds
    s_add_u32 m0, s87, 2048
    s_add_u32 s76, s76, 16384
    buffer_load_dwordx4 v15, s[56:59], s76 offen  lds
    s_mov_b32 exec_hi, 0
    s_add_u32 m0, s87, 3072
    s_add_u32 s76, s76, 16384
    buffer_load_dwordx4 v11, s[56:59], s76 offen  lds
    s_mov_b32 exec_hi, -1
    s_add_u32 s85, s85, 128
    s_add_u32 s87, s87, 16384
    s_cmp_ge_u32 s87, 163840
    s_cselect_b32 s92, 49152, 0
    s_sub_u32 s87, s87, s92
    s_add_u32 m0, s86, 0
    s_nop 0
    buffer_load_dwordx4 v14, s[60:63], s84 offen  lds
    s_add_u32 m0, s86, 896
    s_nop 0
    buffer_load_dwordx4 v14, s[60:63], s84 offen offset:128  lds
    s_add_u32 m0, s86, 1792
    s_nop 0
    buffer_load_dwordx4 v14, s[60:63], s84 offen offset:256  lds
    s_add_u32 m0, s86, 2688
    s_nop 0
    buffer_load_dwordx4 v14, s[60:63], s84 offen offset:384  lds
    s_add_u32 s84, s84, 262144
    s_add_u32 s86, s86, 16384
    s_cmp_ge_u32 s86, 114688
    s_cselect_b32 s92, 81920, 0
    s_sub_u32 s86, s86, s92
    s_waitcnt vmcnt(24)
    s_barrier
    s_add_u32 m0, s86, 0
    s_nop 0
    buffer_load_dwordx4 v14, s[60:63], s84 offen  lds
    s_add_u32 m0, s86, 896
    s_nop 0
    buffer_load_dwordx4 v14, s[60:63], s84 offen offset:128  lds
    s_add_u32 m0, s86, 1792
    s_nop 0
    buffer_load_dwordx4 v14, s[60:63], s84 offen offset:256  lds
    s_add_u32 m0, s86, 2688
    s_nop 0
    buffer_load_dwordx4 v14, s[60:63], s84 offen offset:384  lds
    s_add_u32 s84, s84, 262144
    s_add_u32 s86, s86, 16384
    s_cmp_ge_u32 s86, 114688
    s_cselect_b32 s92, 81920, 0
    s_sub_u32 s86, s86, s92
    buffer_load_dwordx4 v[80:83], v2, s[48:51], s80 offen nt
    buffer_load_dwordx4 v[84:87], v2, s[48:51], s80 offen offset:128 nt
    s_add_u32 s74, s74, 8192
    s_add_u32 s80, s80, 8192
    buffer_load_dwordx4 v[88:91], v2, s[48:51], s80 offen nt
    buffer_load_dwordx4 v[92:95], v2, s[48:51], s80 offen offset:128 nt
    s_add_u32 s74, s74, 24576
    s_cmp_ge_u32 s74, 163840
    s_cselect_b32 s92, 163840, 0
    s_sub_u32 s74, s74, s92
    s_add_u32 s80, s80, 8192
    s_waitcnt vmcnt(24)
    s_barrier
    s_mov_b32 s76, s85
    s_add_u32 m0, s87, 0
    s_nop 0
    buffer_load_dwordx4 v15, s[56:59], s76 offen  lds
    s_add_u32 m0, s87, 1024
    s_add_u32 s76, s76, 16384
    buffer_load_dwordx4 v11, s[56:59], s76 offen  lds
    s_add_u32 m0, s87, 2048
    s_add_u32 s76, s76, 16384
    buffer_load_dwordx4 v15, s[56:59], s76 offen  lds
    s_mov_b32 exec_hi, 0
    s_add_u32 m0, s87, 3072
    s_add_u32 s76, s76, 16384
    buffer_load_dwordx4 v11, s[56:59], s76 offen  lds
    s_mov_b32 exec_hi, -1
    s_add_u32 s85, s85, 128
    s_add_u32 s87, s87, 16384
    s_cmp_ge_u32 s87, 163840
    s_cselect_b32 s92, 49152, 0
    s_sub_u32 s87, s87, s92
    s_add_u32 m0, s86, 0
    s_nop 0
    buffer_load_dwordx4 v14, s[60:63], s84 offen  lds
    s_add_u32 m0, s86, 896
    s_nop 0
    buffer_load_dwordx4 v14, s[60:63], s84 offen offset:128  lds
    s_add_u32 m0, s86, 1792
    s_nop 0
    buffer_load_dwordx4 v14, s[60:63], s84 offen offset:256  lds
    s_add_u32 m0, s86, 2688
    s_nop 0
    buffer_load_dwordx4 v14, s[60:63], s84 offen offset:384  lds
    s_add_u32 s84, s84, 262144
    s_add_u32 s86, s86, 16384
    s_cmp_ge_u32 s86, 114688
    s_cselect_b32 s92, 81920, 0
    s_sub_u32 s86, s86, s92
    s_waitcnt vmcnt(24)
    s_barrier
    s_add_u32 m0, s86, 0
    s_nop 0
    buffer_load_dwordx4 v14, s[60:63], s84 offen  lds
    s_add_u32 m0, s86, 896
    s_nop 0
    buffer_load_dwordx4 v14, s[60:63], s84 offen offset:128  lds
    s_add_u32 m0, s86, 1792
    s_nop 0
    buffer_load_dwordx4 v14, s[60:63], s84 offen offset:256  lds
    s_add_u32 m0, s86, 2688
    s_nop 0
    buffer_load_dwordx4 v14, s[60:63], s84 offen offset:384  lds
    s_add_u32 s84, s84, 262144
    s_add_u32 s86, s86, 16384
    s_cmp_ge_u32 s86, 114688
    s_cselect_b32 s92, 81920, 0
    s_sub_u32 s86, s86, s92
    s_waitcnt vmcnt(20)
    s_barrier
    buffer_load_dwordx4 v[96:99], v3, s[52:55], s81 offen nt
    buffer_load_dwordx4 v[100:103], v3, s[52:55], s81 offen offset:128 nt
    s_add_u32 s75, s75, 8192
    s_add_u32 s81, s81, 8192
    buffer_load_dwordx4 v[104:107], v3, s[52:55], s81 offen nt
    buffer_load_dwordx4 v[108:111], v3, s[52:55], s81 offen offset:128 nt
    s_add_u32 s75, s75, 24576
    s_cmp_ge_u32 s75, 163840
    s_cselect_b32 s92, 163840, 0
    s_sub_u32 s75, s75, s92
    s_add_u32 s81, s81, 8192
    s_waitcnt vmcnt(20)
    s_barrier
    s_waitcnt vmcnt(8)
    s_barrier
    buffer_load_dwordx4 v[112:115], v2, s[48:51], s80 offen nt
    buffer_load_dwordx4 v[116:119], v2, s[48:51], s80 offen offset:128 nt
    s_add_u32 s74, s74, 8192
    s_add_u32 s80, s80, 8192
    s_waitcnt vmcnt(6)
    s_barrier
    buffer_load_dwordx4 v[120:123], v3, s[52:55], s81 offen nt
    buffer_load_dwordx4 v[124:127], v3, s[52:55], s81 offen offset:128 nt
    s_add_u32 s75, s75, 8192
    s_add_u32 s81, s81, 8192
    buffer_load_dwordx4 v[128:131], v2, s[48:51], s80 offen nt
    buffer_load_dwordx4 v[132:135], v2, s[48:51], s80 offen offset:128 nt
    s_add_u32 s74, s74, 24576
    s_cmp_ge_u32 s74, 163840
    s_cselect_b32 s92, 163840, 0
    s_sub_u32 s74, s74, s92
    s_add_u32 s80, s80, 8192
    s_barrier
    buffer_load_dwordx4 v[136:139], v3, s[52:55], s81 offen nt
    buffer_load_dwordx4 v[140:143], v3, s[52:55], s81 offen offset:128 nt
    s_add_u32 s75, s75, 24576
    s_cmp_ge_u32 s75, 163840
    s_cselect_b32 s92, 163840, 0
    s_sub_u32 s75, s75, s92
    s_add_u32 s81, s81, 8192
    buffer_load_dwordx4 v[144:147], v2, s[48:51], s80 offen nt
    buffer_load_dwordx4 v[148:151], v2, s[48:51], s80 offen offset:128 nt
    s_add_u32 s74, s74, 8192
    s_add_u32 s80, s80, 8192
    buffer_load_dwordx4 v[152:155], v3, s[52:55], s81 offen nt
    buffer_load_dwordx4 v[156:159], v3, s[52:55], s81 offen offset:128 nt
    s_add_u32 s75, s75, 8192
    s_add_u32 s81, s81, 8192
    v_mov_b32 v5, 0
    v_and_b32 v6, 7, v1
    v_lshlrev_b32 v6, 3, v6
    s_and_b32 s76, s42, 1
    s_lshl_b32 s76, s76, 2
    s_and_b32 s77, s43, 3
    s_add_u32 s76, s76, s77
    s_lshl_b32 s90, 1, s76
    s_lshr_b32 s77, s42, 1
    s_cmp_eq_u32 s77, s45
    s_cselect_b32 s90, s90, 0
    s_or_b32 s90, s90, 0xffffff00
    s_mov_b32 s91, -1
    s_lshl_b32 s35, s40, 2
    s_add_u32 s35, s35, s41
    s_lshl_b32 s35, s35, 2
    s_add_u32 s93, s35, s45
    s_add_u32 s35, s35, s77
    s_lshl_b32 s35, s35, 8
    s_lshl_b32 s93, s93, 8
    s_lshl_b32 s76, s76, 3
    s_add_u32 s35, s35, s76
    s_add_u32 s56, s32, 25165824
    s_addc_u32 s57, s33, 0
    s_and_b32 s57, s57, 0xffff
    s_mov_b32 s58, 8192
    s_mov_b32 s73, 0
    s_mov_b32 s47, 0
    s_mul_i32 s85, s82, 3584
    s_add_u32 s83, s85, 65536
    s_lshl_b32 s34, s82, 11
    s_lshl_b32 s84, s82, 14
    v_mov_b32 v11, 0x40000000
    s_mul_i32 s76, s46, 56
    v_add_u32 v15, s76, v1
    v_lshlrev_b32 v15, 7, v15
    v_cmp_gt_u32 vcc, 56, v1
    s_nop 1
    v_cndmask_b32 v15, v11, v15, vcc
    v_lshrrev_b32 v14, 1, v1
    s_lshl_b32 s76, s45, 5
    v_add_u32 v14, s76, v14
    v_lshlrev_b32 v14, 11, v14
    v_and_b32 v9, 1, v1
    v_lshl_add_u32 v14, v9, 7, v14
    s_barrier
    v_add_u32 v4, 32768, v12
    ds_write_b128 v4, v[16:19] offset:0
    ds_write_b128 v4, v[20:23] offset:1024
    v_add_u32 v4, 40960, v12
    ds_write_b128 v4, v[24:27] offset:0
    ds_write_b128 v4, v[28:31] offset:1024
    buffer_load_dwordx4 v[160:163], v2, s[48:51], s80 offen nt
    buffer_load_dwordx4 v[164:167], v2, s[48:51], s80 offen offset:128 nt
    s_add_u32 s74, s74, 24576
    s_cmp_ge_u32 s74, 163840
    s_cselect_b32 s92, 163840, 0
    s_sub_u32 s74, s74, s92
    s_add_u32 s80, s80, 8192
    buffer_load_dwordx4 v[168:171], v2, s[48:51], s80 offen nt
    buffer_load_dwordx4 v[172:175], v2, s[48:51], s80 offen offset:128 nt
    s_add_u32 s74, s74, 8192
    s_add_u32 s80, s80, 8192
    s_waitcnt vmcnt(4)
    s_waitcnt lgkmcnt(0)
    s_barrier
    v_add_u32 v4, 65536, v12
    ds_write_b128 v4, v[48:51] offset:0
    ds_write_b128 v4, v[52:55] offset:1024
    v_add_u32 v4, 49152, v12
    ds_write_b128 v4, v[32:35] offset:0
    ds_write_b128 v4, v[36:39] offset:1024
    buffer_load_dwordx4 v[176:179], v2, s[48:51], s80 offen nt
    buffer_load_dwordx4 v[180:183], v2, s[48:51], s80 offen offset:128 nt
    s_add_u32 s74, s74, 24576
    s_cmp_ge_u32 s74, 163840
    s_cselect_b32 s92, 163840, 0
    s_sub_u32 s74, s74, s92
    s_add_u32 s80, s80, 8192
    buffer_load_dwordx4 v[184:187], v3, s[52:55], s81 offen nt
    buffer_load_dwordx4 v[188:191], v3, s[52:55], s81 offen offset:128 nt
    s_add_u32 s75, s75, 24576
    s_cmp_ge_u32 s75, 163840
    s_cselect_b32 s92, 163840, 0
    s_sub_u32 s75, s75, s92
    s_add_u32 s81, s81, 8192
    s_waitcnt vmcnt(4)
    s_waitcnt lgkmcnt(0)
    s_barrier
    v_add_u32 v4, 73728, v12
    ds_write_b128 v4, v[56:59] offset:0
    ds_write_b128 v4, v[60:63] offset:1024
    v_add_u32 v4, 57344, v12
    ds_write_b128 v4, v[40:43] offset:0
    ds_write_b128 v4, v[44:47] offset:1024
    buffer_load_dwordx4 v[192:195], v2, s[48:51], s80 offen nt
    buffer_load_dwordx4 v[196:199], v2, s[48:51], s80 offen offset:128 nt
    s_add_u32 s74, s74, 8192
    s_add_u32 s80, s80, 8192
    buffer_load_dwordx4 v[200:203], v3, s[52:55], s81 offen nt
    buffer_load_dwordx4 v[204:207], v3, s[52:55], s81 offen offset:128 nt
    s_add_u32 s75, s75, 8192
    s_add_u32 s81, s81, 8192
    s_waitcnt vmcnt(4)
    s_waitcnt lgkmcnt(0)
    s_barrier
    v_add_u32 v4, 98304, v12
    ds_write_b128 v4, v[80:83] offset:0
    ds_write_b128 v4, v[84:87] offset:1024
    v_add_u32 v4, 81920, v12
    ds_write_b128 v4, v[64:67] offset:0
    ds_write_b128 v4, v[68:71] offset:1024
    v_add_u32 v4, 106496, v12
    ds_write_b128 v4, v[88:91] offset:0
    ds_write_b128 v4, v[92:95] offset:1024
    v_add_u32 v4, 90112, v12
    ds_write_b128 v4, v[72:75] offset:0
    ds_write_b128 v4, v[76:79] offset:1024
    buffer_load_dwordx4 v[208:211], v2, s[48:51], s80 offen nt
    buffer_load_dwordx4 v[212:215], v2, s[48:51], s80 offen offset:128 nt
    s_add_u32 s74, s74, 24576
    s_cmp_ge_u32 s74, 163840
    s_cselect_b32 s92, 163840, 0
    s_sub_u32 s74, s74, s92
    s_add_u32 s80, s80, 8192
    buffer_load_dwordx4 v[216:219], v3, s[52:55], s81 offen nt
    buffer_load_dwordx4 v[220:223], v3, s[52:55], s81 offen offset:128 nt
    s_add_u32 s75, s75, 24576
    s_cmp_ge_u32 s75, 163840
    s_cselect_b32 s92, 163840, 0
    s_sub_u32 s75, s75, s92
    s_add_u32 s81, s81, 8192
    s_waitcnt vmcnt(4)
    s_waitcnt lgkmcnt(0)
    s_barrier
    v_add_u32 v4, 131072, v12
    ds_write_b128 v4, v[112:115] offset:0
    ds_write_b128 v4, v[116:119] offset:1024
    v_add_u32 v4, 114688, v12
    ds_write_b128 v4, v[96:99] offset:0
    ds_write_b128 v4, v[100:103] offset:1024
    v_add_u32 v4, 139264, v12
    ds_write_b128 v4, v[128:131] offset:0
    ds_write_b128 v4, v[132:135] offset:1024
    v_add_u32 v4, 122880, v12
    ds_write_b128 v4, v[104:107] offset:0
    ds_write_b128 v4, v[108:111] offset:1024
    buffer_load_dwordx4 v[224:227], v2, s[48:51], s80 offen nt
    buffer_load_dwordx4 v[228:231], v2, s[48:51], s80 offen offset:128 nt
    s_add_u32 s74, s74, 8192
    s_add_u32 s80, s80, 8192
    s_waitcnt vmcnt(4)
    s_waitcnt lgkmcnt(0)
    s_barrier
    v_add_u32 v4, 0, v12
    ds_write_b128 v4, v[144:147] offset:0
    ds_write_b128 v4, v[148:151] offset:1024
    v_add_u32 v4, 147456, v12
    ds_write_b128 v4, v[120:123] offset:0
    ds_write_b128 v4, v[124:127] offset:1024
    v_add_u32 v4, 8192, v12
    ds_write_b128 v4, v[160:163] offset:0
    ds_write_b128 v4, v[164:167] offset:1024
    v_add_u32 v4, 155648, v12
    ds_write_b128 v4, v[136:139] offset:0
    ds_write_b128 v4, v[140:143] offset:1024
    buffer_load_dwordx4 v[232:235], v3, s[52:55], s81 offen nt
    buffer_load_dwordx4 v[236:239], v3, s[52:55], s81 offen offset:128 nt
    s_add_u32 s75, s75, 8192
    s_add_u32 s81, s81, 8192
    buffer_load_dwordx4 v[16:19], v2, s[48:51], s80 offen nt
    buffer_load_dwordx4 v[20:23], v2, s[48:51], s80 offen offset:128 nt
    s_add_u32 s74, s74, 24576
    s_cmp_ge_u32 s74, 163840
    s_cselect_b32 s92, 163840, 0
    s_sub_u32 s74, s74, s92
    s_add_u32 s80, s80, 8192
    s_waitcnt vmcnt(4)
    s_waitcnt lgkmcnt(0)
    s_barrier
    v_add_u32 v4, 32768, v12
    ds_write_b128 v4, v[168:171] offset:0
    ds_write_b128 v4, v[172:175] offset:1024
    v_add_u32 v4, 16384, v12
    ds_write_b128 v4, v[152:155] offset:0
    ds_write_b128 v4, v[156:159] offset:1024
    v_add_u32 v4, 40960, v12
    ds_write_b128 v4, v[176:179] offset:0
    ds_write_b128 v4, v[180:183] offset:1024
    v_add_u32 v4, 24576, v12
    ds_write_b128 v4, v[184:187] offset:0
    ds_write_b128 v4, v[188:191] offset:1024
    buffer_load_dwordx4 v[24:27], v3, s[52:55], s81 offen nt
    buffer_load_dwordx4 v[28:31], v3, s[52:55], s81 offen offset:128 nt
    s_add_u32 s75, s75, 24576
    s_cmp_ge_u32 s75, 163840
    s_cselect_b32 s92, 163840, 0
    s_sub_u32 s75, s75, s92
    s_add_u32 s81, s81, 8192
    buffer_load_dwordx4 v[48:51], v2, s[48:51], s80 offen nt
    buffer_load_dwordx4 v[52:55], v2, s[48:51], s80 offen offset:128 nt
    s_add_u32 s74, s74, 8192
    s_add_u32 s80, s80, 8192
    s_waitcnt vmcnt(4)
    s_waitcnt lgkmcnt(0)
    s_barrier
    v_add_u32 v4, 65536, v12
    ds_write_b128 v4, v[192:195] offset:0
    ds_write_b128 v4, v[196:199] offset:1024
    v_add_u32 v4, 49152, v12
    ds_write_b128 v4, v[200:203] offset:0
    ds_write_b128 v4, v[204:207] offset:1024
    v_add_u32 v4, 73728, v12
    ds_write_b128 v4, v[208:211] offset:0
    ds_write_b128 v4, v[212:215] offset:1024
    v_add_u32 v4, 57344, v12
    ds_write_b128 v4, v[216:219] offset:0
    ds_write_b128 v4, v[220:223] offset:1024
    buffer_load_dwordx4 v[32:35], v3, s[52:55], s81 offen nt
    buffer_load_dwordx4 v[36:39], v3, s[52:55], s81 offen offset:128 nt
    s_add_u32 s75, s75, 8192
    s_add_u32 s81, s81, 8192
    buffer_load_dwordx4 v[56:59], v2, s[48:51], s80 offen nt
    buffer_load_dwordx4 v[60:63], v2, s[48:51], s80 offen offset:128 nt
    s_add_u32 s74, s74, 24576
    s_cmp_ge_u32 s74, 163840
    s_cselect_b32 s92, 163840, 0
    s_sub_u32 s74, s74, s92
    s_add_u32 s80, s80, 8192
    s_waitcnt vmcnt(4)
    s_waitcnt lgkmcnt(0)
    s_barrier
    v_add_u32 v4, 98304, v12
    ds_write_b128 v4, v[224:227] offset:0
    ds_write_b128 v4, v[228:231] offset:1024
    buffer_load_dwordx4 v[40:43], v3, s[52:55], s81 offen nt
    buffer_load_dwordx4 v[44:47], v3, s[52:55], s81 offen offset:128 nt
    s_add_u32 s75, s75, 24576
    s_cmp_ge_u32 s75, 163840
    s_cselect_b32 s92, 163840, 0
    s_sub_u32 s75, s75, s92
    s_add_u32 s81, s81, 8192
    buffer_load_dwordx4 v[80:83], v2, s[48:51], s80 offen nt
    buffer_load_dwordx4 v[84:87], v2, s[48:51], s80 offen offset:128 nt
    s_add_u32 s74, s74, 8192
    s_add_u32 s80, s80, 8192
    s_waitcnt vmcnt(4)
    s_waitcnt lgkmcnt(0)
    s_barrier
    v_add_u32 v4, 81920, v12
    ds_write_b128 v4, v[232:235] offset:0
    ds_write_b128 v4, v[236:239] offset:1024
    v_add_u32 v4, 106496, v12
    ds_write_b128 v4, v[16:19] offset:0
    ds_write_b128 v4, v[20:23] offset:1024
    buffer_load_dwordx4 v[64:67], v3, s[52:55], s81 offen nt
    buffer_load_dwordx4 v[68:71], v3, s[52:55], s81 offen offset:128 nt
    s_add_u32 s75, s75, 8192
    s_add_u32 s81, s81, 8192
    s_waitcnt vmcnt(4)
    s_waitcnt lgkmcnt(0)
    s_barrier
    v_add_u32 v4, 90112, v12
    ds_write_b128 v4, v[24:27] offset:0
    ds_write_b128 v4, v[28:31] offset:1024
    v_add_u32 v4, 131072, v12
    ds_write_b128 v4, v[48:51] offset:0
    ds_write_b128 v4, v[52:55] offset:1024
    buffer_load_dwordx4 v[88:91], v2, s[48:51], s80 offen nt
    buffer_load_dwordx4 v[92:95], v2, s[48:51], s80 offen offset:128 nt
    s_add_u32 s74, s74, 24576
    s_cmp_ge_u32 s74, 163840
    s_cselect_b32 s92, 163840, 0
    s_sub_u32 s74, s74, s92
    s_add_u32 s80, s80, 8192
    buffer_load_dwordx4 v[72:75], v3, s[52:55], s81 offen nt
    buffer_load_dwordx4 v[76:79], v3, s[52:55], s81 offen offset:128 nt
    s_add_u32 s75, s75, 24576
    s_cmp_ge_u32 s75, 163840
    s_cselect_b32 s92, 163840, 0
    s_sub_u32 s75, s75, s92
    s_add_u32 s81, s81, 8192
    s_waitcnt vmcnt(4)
    s_waitcnt lgkmcnt(0)
    s_barrier
    v_add_u32 v4, 114688, v12
    ds_write_b128 v4, v[32:35] offset:0
    ds_write_b128 v4, v[36:39] offset:1024
    v_add_u32 v4, 139264, v12
    ds_write_b128 v4, v[56:59] offset:0
    ds_write_b128 v4, v[60:63] offset:1024
    buffer_load_dwordx4 v[112:115], v2, s[48:51], s80 offen nt
    buffer_load_dwordx4 v[116:119], v2, s[48:51], s80 offen offset:128 nt
    s_add_u32 s74, s74, 8192
    s_add_u32 s80, s80, 8192
    buffer_load_dwordx4 v[96:99], v3, s[52:55], s81 offen nt
    buffer_load_dwordx4 v[100:103], v3, s[52:55], s81 offen offset:128 nt
    s_add_u32 s75, s75, 8192
    s_add_u32 s81, s81, 8192
    s_waitcnt vmcnt(4)
    s_waitcnt lgkmcnt(0)
    s_barrier
    v_add_u32 v4, 122880, v12
    ds_write_b128 v4, v[40:43] offset:0
    ds_write_b128 v4, v[44:47] offset:1024
    v_add_u32 v4, 0, v12
    ds_write_b128 v4, v[80:83] offset:0
    ds_write_b128 v4, v[84:87] offset:1024
    buffer_load_dwordx4 v[128:131], v2, s[48:51], s80 offen nt
    buffer_load_dwordx4 v[132:135], v2, s[48:51], s80 offen offset:128 nt
    s_add_u32 s74, s74, 24576
    s_cmp_ge_u32 s74, 163840
    s_cselect_b32 s92, 163840, 0
    s_sub_u32 s74, s74, s92
    s_add_u32 s80, s80, 8192
    buffer_load_dwordx4 v[104:107], v3, s[52:55], s81 offen nt
    buffer_load_dwordx4 v[108:111], v3, s[52:55], s81 offen offset:128 nt
    s_add_u32 s75, s75, 24576
    s_cmp_ge_u32 s75, 163840
    s_cselect_b32 s92, 163840, 0
    s_sub_u32 s75, s75, s92
    s_add_u32 s81, s81, 8192
    s_waitcnt vmcnt(4)
    s_waitcnt lgkmcnt(0)
    s_barrier
    v_add_u32 v4, 147456, v12
    ds_write_b128 v4, v[64:67] offset:0
    ds_write_b128 v4, v[68:71] offset:1024
    buffer_load_dwordx4 v[144:147], v2, s[48:51], s80 offen nt
    buffer_load_dwordx4 v[148:151], v2, s[48:51], s80 offen offset:128 nt
    s_add_u32 s74, s74, 8192
    s_add_u32 s80, s80, 8192
    buffer_load_dwordx4 v[120:123], v3, s[52:55], s81 offen nt
    buffer_load_dwordx4 v[124:127], v3, s[52:55], s81 offen offset:128 nt
    s_add_u32 s75, s75, 8192
    s_add_u32 s81, s81, 8192
    s_waitcnt vmcnt(4)
    s_waitcnt lgkmcnt(0)
    s_barrier
    v_add_u32 v4, 8192, v12
    ds_write_b128 v4, v[88:91] offset:0
    ds_write_b128 v4, v[92:95] offset:1024
    v_add_u32 v4, 155648, v12
    ds_write_b128 v4, v[72:75] offset:0
    ds_write_b128 v4, v[76:79] offset:1024
    buffer_load_dwordx4 v[160:163], v2, s[48:51], s80 offen nt
    buffer_load_dwordx4 v[164:167], v2, s[48:51], s80 offen offset:128 nt
    s_add_u32 s74, s74, 24576
    s_cmp_ge_u32 s74, 163840
    s_cselect_b32 s92, 163840, 0
    s_sub_u32 s74, s74, s92
    s_add_u32 s80, s80, 8192
    s_waitcnt vmcnt(4)
    s_waitcnt lgkmcnt(0)
    s_barrier
    v_add_u32 v4, 32768, v12
    ds_write_b128 v4, v[112:115] offset:0
    ds_write_b128 v4, v[116:119] offset:1024
    v_add_u32 v4, 16384, v12
    ds_write_b128 v4, v[96:99] offset:0
    ds_write_b128 v4, v[100:103] offset:1024
    s_add_u32 m0, s75, 0
    s_nop 0
    buffer_load_dwordx4 v3, s[52:55], s81 offen nt lds
    s_add_u32 m0, s75, 896
    s_nop 0
    buffer_load_dwordx4 v3, s[52:55], s81 offen offset:128 nt lds
    s_add_u32 s75, s75, 24576
    s_cmp_ge_u32 s75, 163840
    s_cselect_b32 s92, 163840, 0
    s_sub_u32 s75, s75, s92
    s_add_u32 s81, s81, 8192
    buffer_load_dwordx4 v[136:139], v2, s[48:51], s80 offen nt
    buffer_load_dwordx4 v[140:143], v2, s[48:51], s80 offen offset:128 nt
    s_add_u32 s74, s74, 8192
    s_add_u32 s80, s80, 8192
    s_waitcnt vmcnt(4)
    s_waitcnt lgkmcnt(0)
    s_barrier
    v_add_u32 v4, 40960, v12
    ds_write_b128 v4, v[128:131] offset:0
    ds_write_b128 v4, v[132:135] offset:1024
    v_add_u32 v4, 24576, v12
    ds_write_b128 v4, v[104:107] offset:0
    ds_write_b128 v4, v[108:111] offset:1024
    s_add_u32 m0, s75, 0
    s_nop 0
    buffer_load_dwordx4 v3, s[52:55], s81 offen nt lds
    s_add_u32 m0, s75, 896
    s_nop 0
    buffer_load_dwordx4 v3, s[52:55], s81 offen offset:128 nt lds
    s_add_u32 s75, s75, 8192
    s_add_u32 s81, s81, 8192
    buffer_load_dwordx4 v[168:171], v2, s[48:51], s80 offen nt
    buffer_load_dwordx4 v[172:175], v2, s[48:51], s80 offen offset:128 nt
    s_add_u32 s74, s74, 24576
    s_cmp_ge_u32 s74, 163840
    s_cselect_b32 s92, 163840, 0
    s_sub_u32 s74, s74, s92
    s_add_u32 s80, s80, 8192
    s_waitcnt vmcnt(4)
    s_waitcnt lgkmcnt(0)
    s_barrier
    v_add_u32 v4, 65536, v12
    ds_write_b128 v4, v[144:147] offset:0
    ds_write_b128 v4, v[148:151] offset:1024
    v_add_u32 v4, 49152, v12
    ds_write_b128 v4, v[120:123] offset:0
    ds_write_b128 v4, v[124:127] offset:1024
    s_add_u32 m0, s75, 0
    s_nop 0
    buffer_load_dwordx4 v3, s[52:55], s81 offen nt lds
    s_add_u32 m0, s75, 896
    s_nop 0
    buffer_load_dwordx4 v3, s[52:55], s81 offen offset:128 nt lds
    s_add_u32 s75, s75, 24576
    s_cmp_ge_u32 s75, 163840
    s_cselect_b32 s92, 163840, 0
    s_sub_u32 s75, s75, s92
    s_add_u32 s81, s81, 8192
    buffer_load_dwordx4 v[152:155], v2, s[48:51], s80 offen nt
    buffer_load_dwordx4 v[156:159], v2, s[48:51], s80 offen offset:128 nt
    s_add_u32 s74, s74, 8192
    s_add_u32 s80, s80, 8192
    s_waitcnt vmcnt(4)
    s_waitcnt lgkmcnt(0)
    s_barrier
    v_add_u32 v4, 73728, v12
    ds_write_b128 v4, v[160:163] offset:0
    ds_write_b128 v4, v[164:167] offset:1024
    s_add_u32 m0, s75, 0
    s_nop 0
    buffer_load_dwordx4 v3, s[52:55], s81 offen nt lds
    s_add_u32 m0, s75, 896
    s_nop 0
    buffer_load_dwordx4 v3, s[52:55], s81 offen offset:128 nt lds
    s_add_u32 s75, s75, 8192
    s_add_u32 s81, s81, 8192
    buffer_load_dwordx4 v[176:179], v2, s[48:51], s80 offen nt
    buffer_load_dwordx4 v[180:183], v2, s[48:51], s80 offen offset:128 nt
    s_add_u32 s74, s74, 24576
    s_cmp_ge_u32 s74, 163840
    s_cselect_b32 s92, 163840, 0
    s_sub_u32 s74, s74, s92
    s_add_u32 s80, s80, 8192
    s_waitcnt vmcnt(4)
    s_waitcnt lgkmcnt(0)
    s_barrier
    v_add_u32 v4, 98304, v12
    ds_write_b128 v4, v[136:139] offset:0
    ds_write_b128 v4, v[140:143] offset:1024
    s_add_u32 m0, s75, 0
    s_nop 0
    buffer_load_dwordx4 v3, s[52:55], s81 offen nt lds
    s_add_u32 m0, s75, 896
    s_nop 0
    buffer_load_dwordx4 v3, s[52:55], s81 offen offset:128 nt lds
    s_add_u32 s75, s75, 24576
    s_cmp_ge_u32 s75, 163840
    s_cselect_b32 s92, 163840, 0
    s_sub_u32 s75, s75, s92
    s_add_u32 s81, s81, 8192
    s_waitcnt vmcnt(4)
    s_waitcnt lgkmcnt(0)
    s_barrier
    v_add_u32 v4, 106496, v12
    ds_write_b128 v4, v[168:171] offset:0
    ds_write_b128 v4, v[172:175] offset:1024
    s_add_u32 m0, s74, 0
    s_nop 0
    buffer_load_dwordx4 v2, s[48:51], s80 offen nt lds
    s_add_u32 m0, s74, 896
    s_nop 0
    buffer_load_dwordx4 v2, s[48:51], s80 offen offset:128 nt lds
    s_add_u32 s74, s74, 8192
    s_add_u32 s80, s80, 8192
    s_add_u32 m0, s75, 0
    s_nop 0
    buffer_load_dwordx4 v3, s[52:55], s81 offen nt lds
    s_add_u32 m0, s75, 896
    s_nop 0
    buffer_load_dwordx4 v3, s[52:55], s81 offen offset:128 nt lds
    s_add_u32 s75, s75, 8192
    s_add_u32 s81, s81, 8192
    buffer_load_dwordx2 v[240:241], v5, s[96:99], 0 offen sc0 sc1
    s_waitcnt vmcnt(3)
    s_waitcnt lgkmcnt(0)
    s_barrier
    v_add_u32 v4, 131072, v12
    ds_write_b128 v4, v[152:155] offset:0
    ds_write_b128 v4, v[156:159] offset:1024
    s_add_u32 m0, s74, 0
    s_nop 0
    buffer_load_dwordx4 v2, s[48:51], s80 offen nt lds
    s_add_u32 m0, s74, 896
    s_nop 0
    buffer_load_dwordx4 v2, s[48:51], s80 offen offset:128 nt lds
    s_add_u32 s74, s74, 24576
    s_cmp_ge_u32 s74, 163840
    s_cselect_b32 s92, 163840, 0
    s_sub_u32 s74, s74, s92
    s_add_u32 s80, s80, 8192
    s_add_u32 m0, s75, 0
    s_nop 0
    buffer_load_dwordx4 v3, s[52:55], s81 offen nt lds
    s_add_u32 m0, s75, 896
    s_nop 0
    buffer_load_dwordx4 v3, s[52:55], s81 offen offset:128 nt lds
    s_add_u32 s75, s75, 24576
    s_cmp_ge_u32 s75, 163840
    s_cselect_b32 s92, 163840, 0
    s_sub_u32 s75, s75, s92
    s_add_u32 s81, s81, 8192
    s_waitcnt vmcnt(4)
    s_waitcnt lgkmcnt(0)
    s_barrier
    v_add_u32 v4, 139264, v12
    ds_write_b128 v4, v[176:179] offset:0
    ds_write_b128 v4, v[180:183] offset:1024
    s_add_u32 m0, s74, 0
    s_nop 0
    buffer_load_dwordx4 v2, s[48:51], s80 offen nt lds
    s_add_u32 m0, s74, 896
    s_nop 0
    buffer_load_dwordx4 v2, s[48:51], s80 offen offset:128 nt lds
    s_add_u32 s74, s74, 8192
    s_add_u32 s80, s80, 8192
    s_add_u32 m0, s75, 0
    s_nop 0
    buffer_load_dwordx4 v3, s[52:55], s81 offen nt lds
    s_add_u32 m0, s75, 896
    s_nop 0
    buffer_load_dwordx4 v3, s[52:55], s81 offen offset:128 nt lds
    s_add_u32 s75, s75, 8192
    s_add_u32 s81, s81, 8192
    s_waitcnt vmcnt(4)
    s_waitcnt lgkmcnt(0)
    s_barrier
    s_add_u32 m0, s74, 0
    s_nop 0
    buffer_load_dwordx4 v2, s[48:51], s80 offen nt lds
    s_add_u32 m0, s74, 896
    s_nop 0
    buffer_load_dwordx4 v2, s[48:51], s80 offen offset:128 nt lds
    s_add_u32 s74, s74, 24576
    s_cmp_ge_u32 s74, 163840
    s_cselect_b32 s92, 163840, 0
    s_sub_u32 s74, s74, s92
    s_add_u32 s80, s80, 8192
    s_add_u32 m0, s75, 0
    s_nop 0
    buffer_load_dwordx4 v3, s[52:55], s81 offen nt lds
    s_add_u32 m0, s75, 896
    s_nop 0
    buffer_load_dwordx4 v3, s[52:55], s81 offen offset:128 nt lds
    s_add_u32 s75, s75, 24576
    s_cmp_ge_u32 s75, 163840
    s_cselect_b32 s92, 163840, 0
    s_sub_u32 s75, s75, s92
    s_add_u32 s81, s81, 8192
    s_waitcnt vmcnt(4)
    s_barrier
    s_add_u32 m0, s74, 0
    s_nop 0
    buffer_load_dwordx4 v2, s[48:51], s80 offen nt lds
    s_add_u32 m0, s74, 896
    s_nop 0
    buffer_load_dwordx4 v2, s[48:51], s80 offen offset:128 nt lds
    s_add_u32 s74, s74, 8192
    s_add_u32 s80, s80, 8192
    s_waitcnt vmcnt(4)
    s_barrier
    s_add_u32 m0, s75, 0
    s_nop 0
    buffer_load_dwordx4 v3, s[52:55], s81 offen nt lds
    s_add_u32 m0, s75, 896
    s_nop 0
    buffer_load_dwordx4 v3, s[52:55], s81 offen offset:128 nt lds
    s_add_u32 s75, s75, 8192
    s_add_u32 s81, s81, 8192
    s_add_u32 m0, s74, 0
    s_nop 0
    buffer_load_dwordx4 v2, s[48:51], s80 offen nt lds
    s_add_u32 m0, s74, 896
    s_nop 0
    buffer_load_dwordx4 v2, s[48:51], s80 offen offset:128 nt lds
    s_add_u32 s74, s74, 24576
    s_cmp_ge_u32 s74, 163840
    s_cselect_b32 s92, 163840, 0
    s_sub_u32 s74, s74, s92
    s_add_u32 s80, s80, 8192
    s_waitcnt vmcnt(4)
    s_barrier
    s_add_u32 m0, s75, 0
    s_nop 0
    buffer_load_dwordx4 v3, s[52:55], s81 offen nt lds
    s_add_u32 m0, s75, 896
    s_nop 0
    buffer_load_dwordx4 v3, s[52:55], s81 offen offset:128 nt lds
    s_add_u32 s75, s75, 24576
    s_cmp_ge_u32 s75, 163840
    s_cselect_b32 s92, 163840, 0
    s_sub_u32 s75, s75, s92
    s_add_u32 s81, s81, 8192
    s_add_u32 m0, s74, 0
    s_nop 0
    buffer_load_dwordx4 v2, s[48:51], s80 offen nt lds
    s_add_u32 m0, s74, 896
    s_nop 0
    buffer_load_dwordx4 v2, s[48:51], s80 offen offset:128 nt lds
    s_add_u32 s74, s74, 8192
    s_add_u32 s80, s80, 8192
    s_waitcnt vmcnt(4)
    s_barrier
    s_add_u32 m0, s75, 0
    s_nop 0
    buffer_load_dwordx4 v3, s[52:55], s81 offen nt lds
    s_add_u32 m0, s75, 896
    s_nop 0
    buffer_load_dwordx4 v3, s[52:55], s81 offen offset:128 nt lds
    s_add_u32 s75, s75, 8192
    s_add_u32 s81, s81, 8192
    s_add_u32 m0, s74, 0
    s_nop 0
    buffer_load_dwordx4 v2, s[48:51], s80 offen nt lds
    s_add_u32 m0, s74, 896
    s_nop 0
    buffer_load_dwordx4 v2, s[48:51], s80 offen offset:128 nt lds
    s_add_u32 s74, s74, 24576
    s_cmp_ge_u32 s74, 163840
    s_cselect_b32 s92, 163840, 0
    s_sub_u32 s74, s74, s92
    s_add_u32 s80, s80, 8192
    s_waitcnt vmcnt(4)
    s_barrier
    s_add_u32 m0, s75, 0
    s_nop 0
    buffer_load_dwordx4 v3, s[52:55], s81 offen nt lds
    s_add_u32 m0, s75, 896
    s_nop 0
    buffer_load_dwordx4 v3, s[52:55], s81 offen offset:128 nt lds
    s_add_u32 s75, s75, 24576
    s_cmp_ge_u32 s75, 163840
    s_cselect_b32 s92, 163840, 0
    s_sub_u32 s75, s75, s92
    s_add_u32 s81, s81, 8192
    s_add_u32 m0, s74, 0
    s_nop 0
    buffer_load_dwordx4 v2, s[48:51], s80 offen nt lds
    s_add_u32 m0, s74, 896
    s_nop 0
    buffer_load_dwordx4 v2, s[48:51], s80 offen offset:128 nt lds
    s_add_u32 s74, s74, 8192
    s_add_u32 s80, s80, 8192
    s_mov_b32 s76, 0x40000
NONCE:
    v_min_u32 v242, v240, v241
    v_cmp_ne_u32 vcc, 0, v242
    s_cbranch_vccnz NONCED
    s_sleep 8
    buffer_load_dwordx2 v[240:241], v5, s[96:99], 0 offen sc0 sc1
    s_waitcnt vmcnt(0)
    s_sub_u32 s76, s76, 1
    s_cbranch_scc0 NONCE
NONCED:
    s_waitcnt vmcnt(4)
    s_barrier
    s_add_u32 m0, s75, 0
    s_nop 0
    buffer_load_dwordx4 v3, s[52:55], s81 offen nt lds
    s_add_u32 m0, s75, 896
    s_nop 0
    buffer_load_dwordx4 v3, s[52:55], s81 offen offset:128 nt lds
    s_add_u32 s75, s75, 8192
    s_add_u32 s81, s81, 8192
    s_waitcnt vmcnt(4)
    s_barrier
    s_add_u32 m0, s74, 0
    s_nop 0
    buffer_load_dwordx4 v2, s[48:51], s80 offen nt lds
    s_add_u32 m0, s74, 896
    s_nop 0
    buffer_load_dwordx4 v2, s[48:51], s80 offen offset:128 nt lds
    s_add_u32 s74, s74, 24576
    s_cmp_ge_u32 s74, 163840
    s_cselect_b32 s92, 163840, 0
    s_sub_u32 s74, s74, s92
    s_add_u32 s80, s80, 8192
    s_add_u32 m0, s75, 0
    s_nop 0
    buffer_load_dwordx4 v3, s[52:55], s81 offen nt lds
    s_add_u32 m0, s75, 896
    s_nop 0
    buffer_load_dwordx4 v3, s[52:55], s81 offen offset:128 nt lds
    s_add_u32 s75, s75, 24576
    s_cmp_ge_u32 s75, 163840
    s_cselect_b32 s92, 163840, 0
    s_sub_u32 s75, s75, s92
    s_add_u32 s81, s81, 8192
    s_waitcnt vmcnt(4)
    s_barrier
    s_add_u32 m0, s74, 0
    s_nop 0
    buffer_load_dwordx4 v2, s[48:51], s80 offen nt lds
    s_add_u32 m0, s74, 896
    s_nop 0
    buffer_load_dwordx4 v2, s[48:51], s80 offen offset:128 nt lds
    s_add_u32 s74, s74, 8192
    s_add_u32 s80, s80, 8192
    s_add_u32 m0, s75, 0
    s_nop 0
    buffer_load_dwordx4 v3, s[52:55], s81 offen nt lds
    s_add_u32 m0, s75, 896
    s_nop 0
    buffer_load_dwordx4 v3, s[52:55], s81 offen offset:128 nt lds
    s_add_u32 s75, s75, 8192
    s_add_u32 s81, s81, 8192
    s_waitcnt vmcnt(4)
    s_barrier
    s_add_u32 m0, s74, 0
    s_nop 0
    buffer_load_dwordx4 v2, s[48:51], s80 offen nt lds
    s_add_u32 m0, s74, 896
    s_nop 0
    buffer_load_dwordx4 v2, s[48:51], s80 offen offset:128 nt lds
    s_add_u32 s74, s74, 24576
    s_cmp_ge_u32 s74, 163840
    s_cselect_b32 s92, 163840, 0
    s_sub_u32 s74, s74, s92
    s_add_u32 s80, s80, 8192
    s_add_u32 m0, s75, 0
    s_nop 0
    buffer_load_dwordx4 v3, s[52:55], s81 offen nt lds
    s_add_u32 m0, s75, 896
    s_nop 0
    buffer_load_dwordx4 v3, s[52:55], s81 offen offset:128 nt lds
    s_add_u32 s75, s75, 24576
    s_cmp_ge_u32 s75, 163840
    s_cselect_b32 s92, 163840, 0
    s_sub_u32 s75, s75, s92
    s_add_u32 s81, s81, 8192
    s_barrier
    s_add_u32 m0, s74, 0
    s_nop 0
    buffer_load_dwordx4 v2, s[48:51], s80 offen nt lds
    s_add_u32 m0, s74, 896
    s_nop 0
    buffer_load_dwordx4 v2, s[48:51], s80 offen offset:128 nt lds
    s_add_u32 s74, s74, 8192
    s_add_u32 s80, s80, 8192
    s_add_u32 m0, s75, 0
    s_nop 0
    buffer_load_dwordx4 v3, s[52:55], s81 offen nt lds
    s_add_u32 m0, s75, 896
    s_nop 0
    buffer_load_dwordx4 v3, s[52:55], s81 offen offset:128 nt lds
    s_add_u32 s75, s75, 8192
    s_add_u32 s81, s81, 8192
    s_waitcnt vmcnt(4)
    s_barrier
    s_add_u32 m0, s74, 0
    s_nop 0
    buffer_load_dwordx4 v2, s[48:51], s80 offen nt lds
    s_add_u32 m0, s74, 896
    s_nop 0
    buffer_load_dwordx4 v2, s[48:51], s80 offen offset:128 nt lds
    s_add_u32 s74, s74, 24576
    s_cmp_ge_u32 s74, 163840
    s_cselect_b32 s92, 163840, 0
    s_sub_u32 s74, s74, s92
    s_add_u32 s80, s80, 8192
    s_cmp_lg_u32 s82, 3
    s_cbranch_scc1 NOSIG0
    s_mov_b64 exec, 1
    buffer_store_dwordx2 v[240:241], v5, s[56:59], s35 offen offset:0 sc0 sc1
    s_mov_b64 exec, -1
NOSIG0:
    s_waitcnt vmcnt(4)
    s_barrier
    s_add_u32 m0, s75, 0
    s_nop 0
    buffer_load_dwordx4 v3, s[52:55], s81 offen nt lds
    s_add_u32 m0, s75, 896
    s_nop 0
    buffer_load_dwordx4 v3, s[52:55], s81 offen offset:128 nt lds
    s_add_u32 s75, s75, 24576
    s_cmp_ge_u32 s75, 163840
    s_cselect_b32 s92, 163840, 0
    s_sub_u32 s75, s75, s92
    s_add_u32 s81, s81, 8192
    s_add_u32 m0, s74, 0
    s_nop 0
    buffer_load_dwordx4 v2, s[48:51], s80 offen nt lds
    s_add_u32 m0, s74, 896
    s_nop 0
    buffer_load_dwordx4 v2, s[48:51], s80 offen offset:128 nt lds
    s_add_u32 s74, s74, 8192
    s_add_u32 s80, s80, 8192
    s_waitcnt vmcnt(4)
    s_barrier
    s_add_u32 m0, s75, 0
    s_nop 0
    buffer_load_dwordx4 v3, s[52:55], s81 offen nt lds
    s_add_u32 m0, s75, 896
    s_nop 0
    buffer_load_dwordx4 v3, s[52:55], s81 offen offset:128 nt lds
    s_add_u32 s75, s75, 8192
    s_add_u32 s81, s81, 8192
    s_add_u32 m0, s74, 0
    s_nop 0
    buffer_load_dwordx4 v2, s[48:51], s80 offen nt lds
    s_add_u32 m0, s74, 896
    s_nop 0
    buffer_load_dwordx4 v2, s[48:51], s80 offen offset:128 nt lds
    s_add_u32 s74, s74, 24576
    s_cmp_ge_u32 s74, 163840
    s_cselect_b32 s92, 163840, 0
    s_sub_u32 s74, s74, s92
    s_add_u32 s80, s80, 8192
    s_waitcnt vmcnt(4)
    s_barrier
    s_add_u32 m0, s75, 0
    s_nop 0
    buffer_load_dwordx4 v3, s[52:55], s81 offen nt lds
    s_add_u32 m0, s75, 896
    s_nop 0
    buffer_load_dwordx4 v3, s[52:55], s81 offen offset:128 nt lds
    s_add_u32 s75, s75, 24576
    s_cmp_ge_u32 s75, 163840
    s_cselect_b32 s92, 163840, 0
    s_sub_u32 s75, s75, s92
    s_add_u32 s81, s81, 8192
    s_add_u32 m0, s74, 0
    s_nop 0
    buffer_load_dwordx4 v2, s[48:51], s80 offen nt lds
    s_add_u32 m0, s74, 896
    s_nop 0
    buffer_load_dwordx4 v2, s[48:51], s80 offen offset:128 nt lds
    s_add_u32 s74, s74, 8192
    s_add_u32 s80, s80, 8192
    s_waitcnt vmcnt(4)
    s_barrier
    s_add_u32 m0, s75, 0
    s_nop 0
    buffer_load_dwordx4 v3, s[52:55], s81 offen nt lds
    s_add_u32 m0, s75, 896
    s_nop 0
    buffer_load_dwordx4 v3, s[52:55], s81 offen offset:128 nt lds
    s_add_u32 s75, s75, 8192
    s_add_u32 s81, s81, 8192
    s_add_u32 m0, s74, 0
    s_nop 0
    buffer_load_dwordx4 v2, s[48:51], s80 offen nt lds
    s_add_u32 m0, s74, 896
    s_nop 0
    buffer_load_dwordx4 v2, s[48:51], s80 offen offset:128 nt lds
    s_add_u32 s74, s74, 24576
    s_cmp_ge_u32 s74, 163840
    s_cselect_b32 s92, 163840, 0
    s_sub_u32 s74, s74, s92
    s_add_u32 s80, s80, 8192
    s_waitcnt vmcnt(4)
    s_barrier
    s_add_u32 m0, s75, 0
    s_nop 0
    buffer_load_dwordx4 v3, s[52:55], s81 offen nt lds
    s_add_u32 m0, s75, 896
    s_nop 0
    buffer_load_dwordx4 v3, s[52:55], s81 offen offset:128 nt lds
    s_add_u32 s75, s75, 24576
    s_cmp_ge_u32 s75, 163840
    s_cselect_b32 s92, 163840, 0
    s_sub_u32 s75, s75, s92
    s_add_u32 s81, s81, 8192
    s_waitcnt vmcnt(4)
    s_barrier
    s_add_u32 m0, s74, 0
    s_nop 0
    buffer_load_dwordx4 v2, s[48:51], s80 offen nt lds
    s_add_u32 m0, s74, 896
    s_nop 0
    buffer_load_dwordx4 v2, s[48:51], s80 offen offset:128 nt lds
    s_add_u32 s74, s74, 8192
    s_add_u32 s80, s80, 8192
    s_add_u32 m0, s75, 0
    s_nop 0
    buffer_load_dwordx4 v3, s[52:55], s81 offen nt lds
    s_add_u32 m0, s75, 896
    s_nop 0
    buffer_load_dwordx4 v3, s[52:55], s81 offen offset:128 nt lds
    s_add_u32 s75, s75, 8192
    s_add_u32 s81, s81, 8192
    s_waitcnt vmcnt(4)
    s_barrier
    s_add_u32 m0, s74, 0
    s_nop 0
    buffer_load_dwordx4 v2, s[48:51], s80 offen nt lds
    s_add_u32 m0, s74, 896
    s_nop 0
    buffer_load_dwordx4 v2, s[48:51], s80 offen offset:128 nt lds
    s_add_u32 s74, s74, 24576
    s_cmp_ge_u32 s74, 163840
    s_cselect_b32 s92, 163840, 0
    s_sub_u32 s74, s74, s92
    s_add_u32 s80, s80, 8192
    s_add_u32 m0, s75, 0
    s_nop 0
    buffer_load_dwordx4 v3, s[52:55], s81 offen nt lds
    s_add_u32 m0, s75, 896
    s_nop 0
    buffer_load_dwordx4 v3, s[52:55], s81 offen offset:128 nt lds
    s_add_u32 s75, s75, 24576
    s_cmp_ge_u32 s75, 163840
    s_cselect_b32 s92, 163840, 0
    s_sub_u32 s75, s75, s92
    s_add_u32 s81, s81, 8192
    s_waitcnt vmcnt(4)
    s_barrier
    s_add_u32 m0, s74, 0
    s_nop 0
    buffer_load_dwordx4 v2, s[48:51], s80 offen nt lds
    s_add_u32 m0, s74, 896
    s_nop 0
    buffer_load_dwordx4 v2, s[48:51], s80 offen offset:128 nt lds
    s_add_u32 s74, s74, 8192
    s_add_u32 s80, s80, 8192
    s_add_u32 m0, s75, 0
    s_nop 0
    buffer_load_dwordx4 v3, s[52:55], s81 offen nt lds
    s_add_u32 m0, s75, 896
    s_nop 0
    buffer_load_dwordx4 v3, s[52:55], s81 offen offset:128 nt lds
    s_add_u32 s75, s75, 8192
    s_add_u32 s81, s81, 8192
    s_waitcnt vmcnt(4)
    s_barrier
    s_add_u32 m0, s74, 0
    s_nop 0
    buffer_load_dwordx4 v2, s[48:51], s80 offen nt lds
    s_add_u32 m0, s74, 896
    s_nop 0
    buffer_load_dwordx4 v2, s[48:51], s80 offen offset:128 nt lds
    s_add_u32 s74, s74, 24576
    s_cmp_ge_u32 s74, 163840
    s_cselect_b32 s92, 163840, 0
    s_sub_u32 s74, s74, s92
    s_add_u32 s80, s80, 8192
    s_add_u32 m0, s75, 0
    s_nop 0
    buffer_load_dwordx4 v3, s[52:55], s81 offen nt lds
    s_add_u32 m0, s75, 896
    s_nop 0
    buffer_load_dwordx4 v3, s[52:55], s81 offen offset:128 nt lds
    s_add_u32 s75, s75, 24576
    s_cmp_ge_u32 s75, 163840
    s_cselect_b32 s92, 163840, 0
    s_sub_u32 s75, s75, s92
    s_add_u32 s81, s81, 8192
    s_waitcnt vmcnt(4)
    s_barrier
    s_add_u32 m0, s74, 0
    s_nop 0
    buffer_load_dwordx4 v2, s[48:51], s80 offen nt lds
    s_add_u32 m0, s74, 896
    s_nop 0
    buffer_load_dwordx4 v2, s[48:51], s80 offen offset:128 nt lds
    s_add_u32 s74, s74, 8192
    s_add_u32 s80, s80, 8192
    s_waitcnt vmcnt(4)
    s_barrier
    s_add_u32 m0, s75, 0
    s_nop 0
    buffer_load_dwordx4 v3, s[52:55], s81 offen nt lds
    s_add_u32 m0, s75, 896
    s_nop 0
    buffer_load_dwordx4 v3, s[52:55], s81 offen offset:128 nt lds
    s_add_u32 s75, s75, 8192
    s_add_u32 s81, s81, 8192
    s_add_u32 m0, s74, 0
    s_nop 0
    buffer_load_dwordx4 v2, s[48:51], s80 offen nt lds
    s_add_u32 m0, s74, 896
    s_nop 0
    buffer_load_dwordx4 v2, s[48:51], s80 offen offset:128 nt lds
    s_add_u32 s74, s74, 24576
    s_cmp_ge_u32 s74, 163840
    s_cselect_b32 s92, 163840, 0
    s_sub_u32 s74, s74, s92
    s_add_u32 s80, s80, 8192
    s_waitcnt vmcnt(4)
    s_barrier
    s_add_u32 m0, s75, 0
    s_nop 0
    buffer_load_dwordx4 v3, s[52:55], s81 offen nt lds
    s_add_u32 m0, s75, 896
    s_nop 0
    buffer_load_dwordx4 v3, s[52:55], s81 offen offset:128 nt lds
    s_add_u32 s75, s75, 24576
    s_cmp_ge_u32 s75, 163840
    s_cselect_b32 s92, 163840, 0
    s_sub_u32 s75, s75, s92
    s_add_u32 s81, s81, 8192
    s_add_u32 m0, s74, 0
    s_nop 0
    buffer_load_dwordx4 v2, s[48:51], s80 offen nt lds
    s_add_u32 m0, s74, 896
    s_nop 0
    buffer_load_dwordx4 v2, s[48:51], s80 offen offset:128 nt lds
    s_add_u32 s74, s74, 8192
    s_add_u32 s80, s80, 8192
    s_waitcnt vmcnt(4)
    s_barrier
    s_add_u32 m0, s75, 0
    s_nop 0
    buffer_load_dwordx4 v3, s[52:55], s81 offen nt lds
    s_add_u32 m0, s75, 896
    s_nop 0
    buffer_load_dwordx4 v3, s[52:55], s81 offen offset:128 nt lds
    s_add_u32 s75, s75, 8192
    s_add_u32 s81, s81, 8192
    s_add_u32 m0, s74, 0
    s_nop 0
    buffer_load_dwordx4 v2, s[48:51], s80 offen nt lds
    s_add_u32 m0, s74, 896
    s_nop 0
    buffer_load_dwordx4 v2, s[48:51], s80 offen offset:128 nt lds
    s_add_u32 s74, s74, 24576
    s_cmp_ge_u32 s74, 163840
    s_cselect_b32 s92, 163840, 0
    s_sub_u32 s74, s74, s92
    s_add_u32 s80, s80, 8192
    s_waitcnt vmcnt(4)
    s_barrier
    s_add_u32 m0, s75, 0
    s_nop 0
    buffer_load_dwordx4 v3, s[52:55], s81 offen nt lds
    s_add_u32 m0, s75, 896
    s_nop 0
    buffer_load_dwordx4 v3, s[52:55], s81 offen offset:128 nt lds
    s_add_u32 s75, s75, 24576
    s_cmp_ge_u32 s75, 163840
    s_cselect_b32 s92, 163840, 0
    s_sub_u32 s75, s75, s92
    s_add_u32 s81, s81, 8192
    s_add_u32 m0, s74, 0
    s_nop 0
    buffer_load_dwordx4 v2, s[48:51], s80 offen nt lds
    s_add_u32 m0, s74, 896
    s_nop 0
    buffer_load_dwordx4 v2, s[48:51], s80 offen offset:128 nt lds
    s_add_u32 s74, s74, 8192
    s_add_u32 s80, s80, 8192
    s_waitcnt vmcnt(4)
    s_barrier
    s_add_u32 m0, s75, 0
    s_nop 0
    buffer_load_dwordx4 v3, s[52:55], s81 offen nt lds
    s_add_u32 m0, s75, 896
    s_nop 0
    buffer_load_dwordx4 v3, s[52:55], s81 offen offset:128 nt lds
    s_add_u32 s75, s75, 8192
    s_add_u32 s81, s81, 8192
    s_waitcnt vmcnt(4)
    s_barrier
    s_add_u32 m0, s74, 0
    s_nop 0
    buffer_load_dwordx4 v2, s[48:51], s80 offen nt lds
    s_add_u32 m0, s74, 896
    s_nop 0
    buffer_load_dwordx4 v2, s[48:51], s80 offen offset:128 nt lds
    s_add_u32 s74, s74, 24576
    s_cmp_ge_u32 s74, 163840
    s_cselect_b32 s92, 163840, 0
    s_sub_u32 s74, s74, s92
    s_add_u32 s80, s80, 8192
    s_add_u32 m0, s75, 0
    s_nop 0
    buffer_load_dwordx4 v3, s[52:55], s81 offen nt lds
    s_add_u32 m0, s75, 896
    s_nop 0
    buffer_load_dwordx4 v3, s[52:55], s81 offen offset:128 nt lds
    s_add_u32 s75, s75, 24576
    s_cmp_ge_u32 s75, 163840
    s_cselect_b32 s92, 163840, 0
    s_sub_u32 s75, s75, s92
    s_add_u32 s81, s81, 8192
    buffer_load_dwordx2 v[242:243], v6, s[56:59], s93 offen offset:0 sc0 sc1
    s_waitcnt vmcnt(3)
    s_barrier
    s_add_u32 m0, s74, 0
    s_nop 0
    buffer_load_dwordx4 v2, s[48:51], s80 offen nt lds
    s_add_u32 m0, s74, 896
    s_nop 0
    buffer_load_dwordx4 v2, s[48:51], s80 offen offset:128 nt lds
    s_add_u32 s74, s74, 8192
    s_add_u32 s80, s80, 8192
    s_add_u32 m0, s75, 0
    s_nop 0
    buffer_load_dwordx4 v3, s[52:55], s81 offen nt lds
    s_add_u32 m0, s75, 896
    s_nop 0
    buffer_load_dwordx4 v3, s[52:55], s81 offen offset:128 nt lds
    s_add_u32 s75, s75, 8192
    s_add_u32 s81, s81, 8192
    s_waitcnt vmcnt(4)
    s_barrier
    s_add_u32 m0, s74, 0
    s_nop 0
    buffer_load_dwordx4 v2, s[48:51], s80 offen nt lds
    s_add_u32 m0, s74, 896
    s_nop 0
    buffer_load_dwordx4 v2, s[48:51], s80 offen offset:128 nt lds
    s_add_u32 s74, s74, 24576
    s_cmp_ge_u32 s74, 163840
    s_cselect_b32 s92, 163840, 0
    s_sub_u32 s74, s74, s92
    s_add_u32 s80, s80, 8192
    s_add_u32 m0, s75, 0
    s_nop 0
    buffer_load_dwordx4 v3, s[52:55], s81 offen nt lds
    s_add_u32 m0, s75, 896
    s_nop 0
    buffer_load_dwordx4 v3, s[52:55], s81 offen offset:128 nt lds
    s_add_u32 s75, s75, 24576
    s_cmp_ge_u32 s75, 163840
    s_cselect_b32 s92, 163840, 0
    s_sub_u32 s75, s75, s92
    s_add_u32 s81, s81, 8192
    s_waitcnt vmcnt(4)
    s_barrier
    s_add_u32 m0, s74, 0
    s_nop 0
    buffer_load_dwordx4 v2, s[48:51], s80 offen nt lds
    s_add_u32 m0, s74, 896
    s_nop 0
    buffer_load_dwordx4 v2, s[48:51], s80 offen offset:128 nt lds
    s_add_u32 s74, s74, 8192
    s_add_u32 s80, s80, 8192
    s_add_u32 m0, s75, 0
    s_nop 0
    buffer_load_dwordx4 v3, s[52:55], s81 offen nt lds
    s_add_u32 m0, s75, 896
    s_nop 0
    buffer_load_dwordx4 v3, s[52:55], s81 offen offset:128 nt lds
    s_add_u32 s75, s75, 8192
    s_add_u32 s81, s81, 8192
    s_waitcnt vmcnt(4)
    s_barrier
    s_add_u32 m0, s74, 0
    s_nop 0
    buffer_load_dwordx4 v2, s[48:51], s80 offen nt lds
    s_add_u32 m0, s74, 896
    s_nop 0
    buffer_load_dwordx4 v2, s[48:51], s80 offen offset:128 nt lds
    s_add_u32 s74, s74, 24576
    s_cmp_ge_u32 s74, 163840
    s_cselect_b32 s92, 163840, 0
    s_sub_u32 s74, s74, s92
    s_add_u32 s80, s80, 8192
    s_waitcnt vmcnt(4)
    s_barrier
    s_add_u32 m0, s75, 0
    s_nop 0
    buffer_load_dwordx4 v3, s[52:55], s81 offen nt lds
    s_add_u32 m0, s75, 896
    s_nop 0
    buffer_load_dwordx4 v3, s[52:55], s81 offen offset:128 nt lds
    s_add_u32 s75, s75, 24576
    s_cmp_ge_u32 s75, 163840
    s_cselect_b32 s92, 163840, 0
    s_sub_u32 s75, s75, s92
    s_add_u32 s81, s81, 8192
    s_add_u32 m0, s74, 0
    s_nop 0
    buffer_load_dwordx4 v2, s[48:51], s80 offen nt lds
    s_add_u32 m0, s74, 896
    s_nop 0
    buffer_load_dwordx4 v2, s[48:51], s80 offen offset:128 nt lds
    s_add_u32 s74, s74, 8192
    s_add_u32 s80, s80, 8192
    s_waitcnt vmcnt(4)
    s_barrier
    s_add_u32 m0, s75, 0
    s_nop 0
    buffer_load_dwordx4 v3, s[52:55], s81 offen nt lds
    s_add_u32 m0, s75, 896
    s_nop 0
    buffer_load_dwordx4 v3, s[52:55], s81 offen offset:128 nt lds
    s_add_u32 s75, s75, 8192
    s_add_u32 s81, s81, 8192
    s_add_u32 m0, s74, 0
    s_nop 0
    buffer_load_dwordx4 v2, s[48:51], s80 offen nt lds
    s_add_u32 m0, s74, 896
    s_nop 0
    buffer_load_dwordx4 v2, s[48:51], s80 offen offset:128 nt lds
    s_add_u32 s74, s74, 24576
    s_cmp_ge_u32 s74, 163840
    s_cselect_b32 s92, 163840, 0
    s_sub_u32 s74, s74, s92
    s_add_u32 s80, s80, 8192
    s_cmp_lg_u32 s82, 3
    s_cbranch_scc1 POLLED0
    s_mov_b32 s76, 0x40000
POLL0:
    v_cmp_eq_u64 vcc, v[242:243], v[240:241]
    s_or_b64 vcc, vcc, s[90:91]
    s_cmp_eq_u64 vcc, -1
    s_cbranch_scc1 POLLED0
    s_sleep 4
    buffer_load_dwordx2 v[242:243], v6, s[56:59], s93 offen offset:0 sc0 sc1
    s_waitcnt vmcnt(0)
    s_sub_u32 s76, s76, 1
    s_cbranch_scc0 POLL0
POLLED0:
    s_waitcnt vmcnt(4)
    s_barrier
    s_add_u32 m0, s75, 0
    s_nop 0
    buffer_load_dwordx4 v3, s[52:55], s81 offen nt lds
    s_add_u32 m0, s75, 896
    s_nop 0
    buffer_load_dwordx4 v3, s[52:55], s81 offen offset:128 nt lds
    s_add_u32 s75, s75, 24576
    s_cmp_ge_u32 s75, 163840
    s_cselect_b32 s92, 163840, 0
    s_sub_u32 s75, s75, s92
    s_add_u32 s81, s81, 8192
    s_add_u32 m0, s75, 0
    s_nop 0
    buffer_load_dwordx4 v3, s[52:55], s81 offen nt lds
    s_add_u32 m0, s75, 896
    s_nop 0
    buffer_load_dwordx4 v3, s[52:55], s81 offen offset:128 nt lds
    s_add_u32 s75, s75, 8192
    s_add_u32 s81, s81, 8192
    s_barrier
    s_add_u32 m0, s75, 0
    s_nop 0
    buffer_load_dwordx4 v3, s[52:55], s81 offen nt lds
    s_add_u32 m0, s75, 896
    s_nop 0
    buffer_load_dwordx4 v3, s[52:55], s81 offen offset:128 nt lds
    s_add_u32 s75, s75, 24576
    s_cmp_ge_u32 s75, 163840
    s_cselect_b32 s92, 163840, 0
    s_sub_u32 s75, s75, s92
    s_add_u32 s81, s81, 8192
    s_lshl_b32 s76, s82, 19
    s_add_u32 s76, s76, 0
    buffer_load_dword v247, v14, s[4:7], s76 offen
    s_barrier
    s_barrier
    s_waitcnt vmcnt(9)
    s_barrier
    s_waitcnt vmcnt(5)
    s_barrier
    s_lshr_b32 s76, s73, 1
    s_and_b32 s76, s76, 6
    s_lshr_b32 s92, s73, 4
    s_add_u32 s76, s76, s92
    s_lshl_b32 s76, s76, 16
    s_and_b32 s92, s73, 3
    s_mul_i32 s92, s92, 14336
    s_add_u32 s76, s76, s92
    s_add_u32 s73, s73, 1
    s_add_u32 s76, s76, s85
    s_add_u32 m0, s83, 0
    s_nop 0
    buffer_load_dwordx4 v10, s[36:39], s76 offen sc1 lds
    s_add_u32 m0, s83, 0
    s_nop 0
    buffer_load_dwordx4 v10, s[36:39], s76 offen offset:1024 sc1 lds
    s_add_u32 m0, s83, 0
    s_nop 0
    buffer_load_dwordx4 v10, s[36:39], s76 offen offset:2048 sc1 lds
    s_mov_b32 exec_hi, 0
    s_add_u32 m0, s83, 0
    s_nop 0
    buffer_load_dwordx4 v10, s[36:39], s76 offen offset:3072 sc1 lds
    s_mov_b32 exec_hi, -1
    s_add_u32 s83, s83, 14336
    s_cmp_ge_u32 s83, 151552
    s_cselect_b32 s92, 86016, 0
    s_sub_u32 s83, s83, s92
    s_lshr_b32 s76, s47, 1
    s_and_b32 s76, s76, 6
    s_lshr_b32 s92, s47, 4
    s_add_u32 s76, s76, s92
    s_lshl_b32 s76, s76, 18
    s_and_b32 s92, s47, 3
    s_mul_i32 s92, s92, 65536
    s_add_u32 s76, s76, s92
    s_add_u32 s47, s47, 1
    s_add_u32 s76, s76, s84
    s_add_u32 m0, s34, 0
    s_nop 0
    buffer_load_dwordx4 v13, s[4:7], s76 offen  lds
    s_add_u32 m0, s34, 896
    s_nop 0
    buffer_load_dwordx4 v13, s[4:7], s76 offen offset:128  lds
    s_add_u32 s34, s34, 8192
    s_and_b32 s34, s34, 65535
    s_lshr_b32 s76, s73, 1
    s_and_b32 s76, s76, 6
    s_lshr_b32 s92, s73, 4
    s_add_u32 s76, s76, s92
    s_lshl_b32 s76, s76, 16
    s_and_b32 s92, s73, 3
    s_mul_i32 s92, s92, 14336
    s_add_u32 s76, s76, s92
    s_add_u32 s73, s73, 1
    s_add_u32 s76, s76, s85
    s_add_u32 m0, s83, 0
    s_nop 0
    buffer_load_dwordx4 v10, s[36:39], s76 offen sc1 lds
    s_add_u32 m0, s83, 0
    s_nop 0
    buffer_load_dwordx4 v10, s[36:39], s76 offen offset:1024 sc1 lds
    s_add_u32 m0, s83, 0
    s_nop 0
    buffer_load_dwordx4 v10, s[36:39], s76 offen offset:2048 sc1 lds
    s_mov_b32 exec_hi, 0
    s_add_u32 m0, s83, 0
    s_nop 0
    buffer_load_dwordx4 v10, s[36:39], s76 offen offset:3072 sc1 lds
    s_mov_b32 exec_hi, -1
    s_add_u32 s83, s83, 14336
    s_cmp_ge_u32 s83, 151552
    s_cselect_b32 s92, 86016, 0
    s_sub_u32 s83, s83, s92
    s_lshr_b32 s76, s47, 1
    s_and_b32 s76, s76, 6
    s_lshr_b32 s92, s47, 4
    s_add_u32 s76, s76, s92
    s_lshl_b32 s76, s76, 18
    s_and_b32 s92, s47, 3
    s_mul_i32 s92, s92, 65536
    s_add_u32 s76, s76, s92
    s_add_u32 s47, s47, 1
    s_add_u32 s76, s76, s84
    s_add_u32 m0, s34, 0
    s_nop 0
    buffer_load_dwordx4 v13, s[4:7], s76 offen  lds
    s_add_u32 m0, s34, 896
    s_nop 0
    buffer_load_dwordx4 v13, s[4:7], s76 offen offset:128  lds
    s_add_u32 s34, s34, 8192
    s_and_b32 s34, s34, 65535
    s_waitcnt vmcnt(15)
    s_barrier
    s_lshr_b32 s76, s73, 1
    s_and_b32 s76, s76, 6
    s_lshr_b32 s92, s73, 4
    s_add_u32 s76, s76, s92
    s_lshl_b32 s76, s76, 16
    s_and_b32 s92, s73, 3
    s_mul_i32 s92, s92, 14336
    s_add_u32 s76, s76, s92
    s_add_u32 s73, s73, 1
    s_add_u32 s76, s76, s85
    s_add_u32 m0, s83, 0
    s_nop 0
    buffer_load_dwordx4 v10, s[36:39], s76 offen sc1 lds
    s_add_u32 m0, s83, 0
    s_nop 0
    buffer_load_dwordx4 v10, s[36:39], s76 offen offset:1024 sc1 lds
    s_add_u32 m0, s83, 0
    s_nop 0
    buffer_load_dwordx4 v10, s[36:39], s76 offen offset:2048 sc1 lds
    s_mov_b32 exec_hi, 0
    s_add_u32 m0, s83, 0
    s_nop 0
    buffer_load_dwordx4 v10, s[36:39], s76 offen offset:3072 sc1 lds
    s_mov_b32 exec_hi, -1
    s_add_u32 s83, s83, 14336
    s_cmp_ge_u32 s83, 151552
    s_cselect_b32 s92, 86016, 0
    s_sub_u32 s83, s83, s92
    s_lshr_b32 s76, s47, 1
    s_and_b32 s76, s76, 6
    s_lshr_b32 s92, s47, 4
    s_add_u32 s76, s76, s92
    s_lshl_b32 s76, s76, 18
    s_and_b32 s92, s47, 3
    s_mul_i32 s92, s92, 65536
    s_add_u32 s76, s76, s92
    s_add_u32 s47, s47, 1
    s_add_u32 s76, s76, s84
    s_add_u32 m0, s34, 0
    s_nop 0
    buffer_load_dwordx4 v13, s[4:7], s76 offen  lds
    s_add_u32 m0, s34, 896
    s_nop 0
    buffer_load_dwordx4 v13, s[4:7], s76 offen offset:128  lds
    s_add_u32 s34, s34, 8192
    s_and_b32 s34, s34, 65535
    s_lshr_b32 s76, s73, 1
    s_and_b32 s76, s76, 6
    s_lshr_b32 s92, s73, 4
    s_add_u32 s76, s76, s92
    s_lshl_b32 s76, s76, 16
    s_and_b32 s92, s73, 3
    s_mul_i32 s92, s92, 14336
    s_add_u32 s76, s76, s92
    s_add_u32 s73, s73, 1
    s_add_u32 s76, s76, s85
    s_add_u32 m0, s83, 0
    s_nop 0
    buffer_load_dwordx4 v10, s[36:39], s76 offen sc1 lds
    s_add_u32 m0, s83, 0
    s_nop 0
    buffer_load_dwordx4 v10, s[36:39], s76 offen offset:1024 sc1 lds
    s_add_u32 m0, s83, 0
    s_nop 0
    buffer_load_dwordx4 v10, s[36:39], s76 offen offset:2048 sc1 lds
    s_mov_b32 exec_hi, 0
    s_add_u32 m0, s83, 0
    s_nop 0
    buffer_load_dwordx4 v10, s[36:39], s76 offen offset:3072 sc1 lds
    s_mov_b32 exec_hi, -1
    s_add_u32 s83, s83, 14336
    s_cmp_ge_u32 s83, 151552
    s_cselect_b32 s92, 86016, 0
    s_sub_u32 s83, s83, s92
    s_lshr_b32 s76, s47, 1
    s_and_b32 s76, s76, 6
    s_lshr_b32 s92, s47, 4
    s_add_u32 s76, s76, s92
    s_lshl_b32 s76, s76, 18
    s_and_b32 s92, s47, 3
    s_mul_i32 s92, s92, 65536
    s_add_u32 s76, s76, s92
    s_add_u32 s47, s47, 1
    s_add_u32 s76, s76, s84
    s_add_u32 m0, s34, 0
    s_nop 0
    buffer_load_dwordx4 v13, s[4:7], s76 offen  lds
    s_add_u32 m0, s34, 896
    s_nop 0
    buffer_load_dwordx4 v13, s[4:7], s76 offen offset:128  lds
    s_add_u32 s34, s34, 8192
    s_and_b32 s34, s34, 65535
    s_waitcnt vmcnt(25)
    s_barrier
    s_lshr_b32 s76, s73, 1
    s_and_b32 s76, s76, 6
    s_lshr_b32 s92, s73, 4
    s_add_u32 s76, s76, s92
    s_lshl_b32 s76, s76, 16
    s_and_b32 s92, s73, 3
    s_mul_i32 s92, s92, 14336
    s_add_u32 s76, s76, s92
    s_add_u32 s73, s73, 1
    s_add_u32 s76, s76, s85
    s_add_u32 m0, s83, 0
    s_nop 0
    buffer_load_dwordx4 v10, s[36:39], s76 offen sc1 lds
    s_add_u32 m0, s83, 0
    s_nop 0
    buffer_load_dwordx4 v10, s[36:39], s76 offen offset:1024 sc1 lds
    s_add_u32 m0, s83, 0
    s_nop 0
    buffer_load_dwordx4 v10, s[36:39], s76 offen offset:2048 sc1 lds
    s_mov_b32 exec_hi, 0
    s_add_u32 m0, s83, 0
    s_nop 0
    buffer_load_dwordx4 v10, s[36:39], s76 offen offset:3072 sc1 lds
    s_mov_b32 exec_hi, -1
    s_add_u32 s83, s83, 14336
    s_cmp_ge_u32 s83, 151552
    s_cselect_b32 s92, 86016, 0
    s_sub_u32 s83, s83, s92
    s_lshr_b32 s76, s47, 1
    s_and_b32 s76, s76, 6
    s_lshr_b32 s92, s47, 4
    s_add_u32 s76, s76, s92
    s_lshl_b32 s76, s76, 18
    s_and_b32 s92, s47, 3
    s_mul_i32 s92, s92, 65536
    s_add_u32 s76, s76, s92
    s_add_u32 s47, s47, 1
    s_add_u32 s76, s76, s84
    s_add_u32 m0, s34, 0
    s_nop 0
    buffer_load_dwordx4 v13, s[4:7], s76 offen  lds
    s_add_u32 m0, s34, 896
    s_nop 0
    buffer_load_dwordx4 v13, s[4:7], s76 offen offset:128  lds
    s_add_u32 s34, s34, 8192
    s_and_b32 s34, s34, 65535
    s_lshr_b32 s76, s73, 1
    s_and_b32 s76, s76, 6
    s_lshr_b32 s92, s73, 4
    s_add_u32 s76, s76, s92
    s_lshl_b32 s76, s76, 16
    s_and_b32 s92, s73, 3
    s_mul_i32 s92, s92, 14336
    s_add_u32 s76, s76, s92
    s_add_u32 s73, s73, 1
    s_add_u32 s76, s76, s85
    s_add_u32 m0, s83, 0
    s_nop 0
    buffer_load_dwordx4 v10, s[36:39], s76 offen sc1 lds
    s_add_u32 m0, s83, 0
    s_nop 0
    buffer_load_dwordx4 v10, s[36:39], s76 offen offset:1024 sc1 lds
    s_add_u32 m0, s83, 0
    s_nop 0
    buffer_load_dwordx4 v10, s[36:39], s76 offen offset:2048 sc1 lds
    s_mov_b32 exec_hi, 0
    s_add_u32 m0, s83, 0
    s_nop 0
    buffer_load_dwordx4 v10, s[36:39], s76 offen offset:3072 sc1 lds
    s_mov_b32 exec_hi, -1
    s_add_u32 s83, s83, 14336
    s_cmp_ge_u32 s83, 151552
    s_cselect_b32 s92, 86016, 0
    s_sub_u32 s83, s83, s92
    s_lshr_b32 s76, s47, 1
    s_and_b32 s76, s76, 6
    s_lshr_b32 s92, s47, 4
    s_add_u32 s76, s76, s92
    s_lshl_b32 s76, s76, 18
    s_and_b32 s92, s47, 3
    s_mul_i32 s92, s92, 65536
    s_add_u32 s76, s76, s92
    s_add_u32 s47, s47, 1
    s_add_u32 s76, s76, s84
    s_add_u32 m0, s34, 0
    s_nop 0
    buffer_load_dwordx4 v13, s[4:7], s76 offen  lds
    s_add_u32 m0, s34, 896
    s_nop 0
    buffer_load_dwordx4 v13, s[4:7], s76 offen offset:128  lds
    s_add_u32 s34, s34, 8192
    s_and_b32 s34, s34, 65535
    s_waitcnt vmcnt(30)
    s_barrier
    s_cmp_lg_u32 s45, 0
    s_cbranch_scc1 WS0
    s_lshl_b32 s76, s82, 19
    s_add_u32 s76, s76, 262144
    buffer_load_dword v247, v14, s[4:7], s76 offen
WS0:
    s_lshr_b32 s76, s47, 1
    s_and_b32 s76, s76, 6
    s_lshr_b32 s92, s47, 4
    s_add_u32 s76, s76, s92
    s_lshl_b32 s76, s76, 18
    s_and_b32 s92, s47, 3
    s_mul_i32 s92, s92, 65536
    s_add_u32 s76, s76, s92
    s_add_u32 s47, s47, 1
    s_add_u32 s76, s76, s84
    s_add_u32 m0, s34, 0
    s_nop 0
    buffer_load_dwordx4 v13, s[4:7], s76 offen  lds
    s_add_u32 m0, s34, 896
    s_nop 0
    buffer_load_dwordx4 v13, s[4:7], s76 offen offset:128  lds
    s_add_u32 s34, s34, 8192
    s_and_b32 s34, s34, 65535
    s_lshr_b32 s76, s47, 1
    s_and_b32 s76, s76, 6
    s_lshr_b32 s92, s47, 4
    s_add_u32 s76, s76, s92
    s_lshl_b32 s76, s76, 18
    s_and_b32 s92, s47, 3
    s_mul_i32 s92, s92, 65536
    s_add_u32 s76, s76, s92
    s_add_u32 s47, s47, 1
    s_add_u32 s76, s76, s84
    s_add_u32 m0, s34, 0
    s_nop 0
    buffer_load_dwordx4 v13, s[4:7], s76 offen  lds
    s_add_u32 m0, s34, 896
    s_nop 0
    buffer_load_dwordx4 v13, s[4:7], s76 offen offset:128  lds
    s_add_u32 s34, s34, 8192
    s_and_b32 s34, s34, 65535
    s_waitcnt vmcnt(28)
    s_barrier
    s_lshr_b32 s76, s73, 1
    s_and_b32 s76, s76, 6
    s_lshr_b32 s92, s73, 4
    s_add_u32 s76, s76, s92
    s_lshl_b32 s76, s76, 16
    s_and_b32 s92, s73, 3
    s_mul_i32 s92, s92, 14336
    s_add_u32 s76, s76, s92
    s_add_u32 s73, s73, 1
    s_add_u32 s76, s76, s85
    s_add_u32 m0, s83, 0
    s_nop 0
    buffer_load_dwordx4 v10, s[36:39], s76 offen sc1 lds
    s_add_u32 m0, s83, 0
    s_nop 0
    buffer_load_dwordx4 v10, s[36:39], s76 offen offset:1024 sc1 lds
    s_add_u32 m0, s83, 0
    s_nop 0
    buffer_load_dwordx4 v10, s[36:39], s76 offen offset:2048 sc1 lds
    s_mov_b32 exec_hi, 0
    s_add_u32 m0, s83, 0
    s_nop 0
    buffer_load_dwordx4 v10, s[36:39], s76 offen offset:3072 sc1 lds
    s_mov_b32 exec_hi, -1
    s_add_u32 s83, s83, 14336
    s_cmp_ge_u32 s83, 151552
    s_cselect_b32 s92, 86016, 0
    s_sub_u32 s83, s83, s92
    s_lshr_b32 s76, s47, 1
    s_and_b32 s76, s76, 6
    s_lshr_b32 s92, s47, 4
    s_add_u32 s76, s76, s92
    s_lshl_b32 s76, s76, 18
    s_and_b32 s92, s47, 3
    s_mul_i32 s92, s92, 65536
    s_add_u32 s76, s76, s92
    s_add_u32 s47, s47, 1
    s_add_u32 s76, s76, s84
    s_add_u32 m0, s34, 0
    s_nop 0
    buffer_load_dwordx4 v13, s[4:7], s76 offen  lds
    s_add_u32 m0, s34, 896
    s_nop 0
    buffer_load_dwordx4 v13, s[4:7], s76 offen offset:128  lds
    s_add_u32 s34, s34, 8192
    s_and_b32 s34, s34, 65535
    s_waitcnt vmcnt(28)
    s_barrier
    s_cmp_lg_u32 s45, 1
    s_cbranch_scc1 WS1
    s_lshl_b32 s76, s82, 19
    s_add_u32 s76, s76, 262144
    buffer_load_dword v247, v14, s[4:7], s76 offen
WS1:
    s_lshr_b32 s76, s73, 1
    s_and_b32 s76, s76, 6
    s_lshr_b32 s92, s73, 4
    s_add_u32 s76, s76, s92
    s_lshl_b32 s76, s76, 16
    s_and_b32 s92, s73, 3
    s_mul_i32 s92, s92, 14336
    s_add_u32 s76, s76, s92
    s_add_u32 s73, s73, 1
    s_add_u32 s76, s76, s85
    s_add_u32 m0, s83, 0
    s_nop 0
    buffer_load_dwordx4 v10, s[36:39], s76 offen sc1 lds
    s_add_u32 m0, s83, 0
    s_nop 0
    buffer_load_dwordx4 v10, s[36:39], s76 offen offset:1024 sc1 lds
    s_add_u32 m0, s83, 0
    s_nop 0
    buffer_load_dwordx4 v10, s[36:39], s76 offen offset:2048 sc1 lds
    s_mov_b32 exec_hi, 0
    s_add_u32 m0, s83, 0
    s_nop 0
    buffer_load_dwordx4 v10, s[36:39], s76 offen offset:3072 sc1 lds
    s_mov_b32 exec_hi, -1
    s_add_u32 s83, s83, 14336
    s_cmp_ge_u32 s83, 151552
    s_cselect_b32 s92, 86016, 0
    s_sub_u32 s83, s83, s92
    s_lshr_b32 s76, s47, 1
    s_and_b32 s76, s76, 6
    s_lshr_b32 s92, s47, 4
    s_add_u32 s76, s76, s92
    s_lshl_b32 s76, s76, 18
    s_and_b32 s92, s47, 3
    s_mul_i32 s92, s92, 65536
    s_add_u32 s76, s76, s92
    s_add_u32 s47, s47, 1
    s_add_u32 s76, s76, s84
    s_add_u32 m0, s34, 0
    s_nop 0
    buffer_load_dwordx4 v13, s[4:7], s76 offen  lds
    s_add_u32 m0, s34, 896
    s_nop 0
    buffer_load_dwordx4 v13, s[4:7], s76 offen offset:128  lds
    s_add_u32 s34, s34, 8192
    s_and_b32 s34, s34, 65535
    s_waitcnt vmcnt(28)
    s_barrier
    s_lshr_b32 s76, s73, 1
    s_and_b32 s76, s76, 6
    s_lshr_b32 s92, s73, 4
    s_add_u32 s76, s76, s92
    s_lshl_b32 s76, s76, 16
    s_and_b32 s92, s73, 3
    s_mul_i32 s92, s92, 14336
    s_add_u32 s76, s76, s92
    s_add_u32 s73, s73, 1
    s_add_u32 s76, s76, s85
    s_add_u32 m0, s83, 0
    s_nop 0
    buffer_load_dwordx4 v10, s[36:39], s76 offen sc1 lds
    s_add_u32 m0, s83, 0
    s_nop 0
    buffer_load_dwordx4 v10, s[36:39], s76 offen offset:1024 sc1 lds
    s_add_u32 m0, s83, 0
    s_nop 0
    buffer_load_dwordx4 v10, s[36:39], s76 offen offset:2048 sc1 lds
    s_mov_b32 exec_hi, 0
    s_add_u32 m0, s83, 0
    s_nop 0
    buffer_load_dwordx4 v10, s[36:39], s76 offen offset:3072 sc1 lds
    s_mov_b32 exec_hi, -1
    s_add_u32 s83, s83, 14336
    s_cmp_ge_u32 s83, 151552
    s_cselect_b32 s92, 86016, 0
    s_sub_u32 s83, s83, s92
    s_lshr_b32 s76, s47, 1
    s_and_b32 s76, s76, 6
    s_lshr_b32 s92, s47, 4
    s_add_u32 s76, s76, s92
    s_lshl_b32 s76, s76, 18
    s_and_b32 s92, s47, 3
    s_mul_i32 s92, s92, 65536
    s_add_u32 s76, s76, s92
    s_add_u32 s47, s47, 1
    s_add_u32 s76, s76, s84
    s_add_u32 m0, s34, 0
    s_nop 0
    buffer_load_dwordx4 v13, s[4:7], s76 offen  lds
    s_add_u32 m0, s34, 896
    s_nop 0
    buffer_load_dwordx4 v13, s[4:7], s76 offen offset:128  lds
    s_add_u32 s34, s34, 8192
    s_and_b32 s34, s34, 65535
    s_waitcnt vmcnt(28)
    s_barrier
    s_cmp_lg_u32 s45, 2
    s_cbranch_scc1 WS2
    s_lshl_b32 s76, s82, 19
    s_add_u32 s76, s76, 262144
    buffer_load_dword v247, v14, s[4:7], s76 offen
WS2:
    s_lshr_b32 s76, s73, 1
    s_and_b32 s76, s76, 6
    s_lshr_b32 s92, s73, 4
    s_add_u32 s76, s76, s92
    s_lshl_b32 s76, s76, 16
    s_and_b32 s92, s73, 3
    s_mul_i32 s92, s92, 14336
    s_add_u32 s76, s76, s92
    s_add_u32 s73, s73, 1
    s_add_u32 s76, s76, s85
    s_add_u32 m0, s83, 0
    s_nop 0
    buffer_load_dwordx4 v10, s[36:39], s76 offen sc1 lds
    s_add_u32 m0, s83, 0
    s_nop 0
    buffer_load_dwordx4 v10, s[36:39], s76 offen offset:1024 sc1 lds
    s_add_u32 m0, s83, 0
    s_nop 0
    buffer_load_dwordx4 v10, s[36:39], s76 offen offset:2048 sc1 lds
    s_mov_b32 exec_hi, 0
    s_add_u32 m0, s83, 0
    s_nop 0
    buffer_load_dwordx4 v10, s[36:39], s76 offen offset:3072 sc1 lds
    s_mov_b32 exec_hi, -1
    s_add_u32 s83, s83, 14336
    s_cmp_ge_u32 s83, 151552
    s_cselect_b32 s92, 86016, 0
    s_sub_u32 s83, s83, s92
    s_lshr_b32 s76, s47, 1
    s_and_b32 s76, s76, 6
    s_lshr_b32 s92, s47, 4
    s_add_u32 s76, s76, s92
    s_lshl_b32 s76, s76, 18
    s_and_b32 s92, s47, 3
    s_mul_i32 s92, s92, 65536
    s_add_u32 s76, s76, s92
    s_add_u32 s47, s47, 1
    s_add_u32 s76, s76, s84
    s_add_u32 m0, s34, 0
    s_nop 0
    buffer_load_dwordx4 v13, s[4:7], s76 offen  lds
    s_add_u32 m0, s34, 896
    s_nop 0
    buffer_load_dwordx4 v13, s[4:7], s76 offen offset:128  lds
    s_add_u32 s34, s34, 8192
    s_and_b32 s34, s34, 65535
    s_waitcnt vmcnt(28)
    s_barrier
    s_lshr_b32 s76, s73, 1
    s_and_b32 s76, s76, 6
    s_lshr_b32 s92, s73, 4
    s_add_u32 s76, s76, s92
    s_lshl_b32 s76, s76, 16
    s_and_b32 s92, s73, 3
    s_mul_i32 s92, s92, 14336
    s_add_u32 s76, s76, s92
    s_add_u32 s73, s73, 1
    s_add_u32 s76, s76, s85
    s_add_u32 m0, s83, 0
    s_nop 0
    buffer_load_dwordx4 v10, s[36:39], s76 offen sc1 lds
    s_add_u32 m0, s83, 0
    s_nop 0
    buffer_load_dwordx4 v10, s[36:39], s76 offen offset:1024 sc1 lds
    s_add_u32 m0, s83, 0
    s_nop 0
    buffer_load_dwordx4 v10, s[36:39], s76 offen offset:2048 sc1 lds
    s_mov_b32 exec_hi, 0
    s_add_u32 m0, s83, 0
    s_nop 0
    buffer_load_dwordx4 v10, s[36:39], s76 offen offset:3072 sc1 lds
    s_mov_b32 exec_hi, -1
    s_add_u32 s83, s83, 14336
    s_cmp_ge_u32 s83, 151552
    s_cselect_b32 s92, 86016, 0
    s_sub_u32 s83, s83, s92
    s_lshr_b32 s76, s47, 1
    s_and_b32 s76, s76, 6
    s_lshr_b32 s92, s47, 4
    s_add_u32 s76, s76, s92
    s_lshl_b32 s76, s76, 18
    s_and_b32 s92, s47, 3
    s_mul_i32 s92, s92, 65536
    s_add_u32 s76, s76, s92
    s_add_u32 s47, s47, 1
    s_add_u32 s76, s76, s84
    s_add_u32 m0, s34, 0
    s_nop 0
    buffer_load_dwordx4 v13, s[4:7], s76 offen  lds
    s_add_u32 m0, s34, 896
    s_nop 0
    buffer_load_dwordx4 v13, s[4:7], s76 offen offset:128  lds
    s_add_u32 s34, s34, 8192
    s_and_b32 s34, s34, 65535
    s_cmp_lg_u32 s82, 3
    s_cbranch_scc1 NOSIG1
    s_mov_b64 exec, 1
    buffer_store_dwordx2 v[240:241], v5, s[56:59], s35 offen offset:128 sc0 sc1
    s_mov_b64 exec, -1
NOSIG1:
    s_waitcnt vmcnt(26)
    s_barrier
    s_cmp_lg_u32 s45, 3
    s_cbranch_scc1 WS3
    s_lshl_b32 s76, s82, 19
    s_add_u32 s76, s76, 262144
    buffer_load_dword v247, v14, s[4:7], s76 offen
WS3:
    s_lshr_b32 s76, s73, 1
    s_and_b32 s76, s76, 6
    s_lshr_b32 s92, s73, 4
    s_add_u32 s76, s76, s92
    s_lshl_b32 s76, s76, 16
    s_and_b32 s92, s73, 3
    s_mul_i32 s92, s92, 14336
    s_add_u32 s76, s76, s92
    s_add_u32 s73, s73, 1
    s_add_u32 s76, s76, s85
    s_add_u32 m0, s83, 0
    s_nop 0
    buffer_load_dwordx4 v10, s[36:39], s76 offen sc1 lds
    s_add_u32 m0, s83, 0
    s_nop 0
    buffer_load_dwordx4 v10, s[36:39], s76 offen offset:1024 sc1 lds
    s_add_u32 m0, s83, 0
    s_nop 0
    buffer_load_dwordx4 v10, s[36:39], s76 offen offset:2048 sc1 lds
    s_mov_b32 exec_hi, 0
    s_add_u32 m0, s83, 0
    s_nop 0
    buffer_load_dwordx4 v10, s[36:39], s76 offen offset:3072 sc1 lds
    s_mov_b32 exec_hi, -1
    s_add_u32 s83, s83, 14336
    s_cmp_ge_u32 s83, 151552
    s_cselect_b32 s92, 86016, 0
    s_sub_u32 s83, s83, s92
    s_lshr_b32 s76, s47, 1
    s_and_b32 s76, s76, 6
    s_lshr_b32 s92, s47, 4
    s_add_u32 s76, s76, s92
    s_lshl_b32 s76, s76, 18
    s_and_b32 s92, s47, 3
    s_mul_i32 s92, s92, 65536
    s_add_u32 s76, s76, s92
    s_add_u32 s47, s47, 1
    s_add_u32 s76, s76, s84
    s_add_u32 m0, s34, 0
    s_nop 0
    buffer_load_dwordx4 v13, s[4:7], s76 offen  lds
    s_add_u32 m0, s34, 896
    s_nop 0
    buffer_load_dwordx4 v13, s[4:7], s76 offen offset:128  lds
    s_add_u32 s34, s34, 8192
    s_and_b32 s34, s34, 65535
    buffer_load_dwordx2 v[242:243], v6, s[56:59], s93 offen offset:128 sc0 sc1
    s_waitcnt vmcnt(27)
    s_barrier
    s_mov_b32 s72, 3
H_L0:
    s_lshr_b32 s76, s73, 1
    s_and_b32 s76, s76, 6
    s_lshr_b32 s92, s73, 4
    s_add_u32 s76, s76, s92
    s_lshl_b32 s76, s76, 16
    s_and_b32 s92, s73, 3
    s_mul_i32 s92, s92, 14336
    s_add_u32 s76, s76, s92
    s_add_u32 s73, s73, 1
    s_add_u32 s76, s76, s85
    s_add_u32 m0, s83, 0
    s_nop 0
    buffer_load_dwordx4 v10, s[36:39], s76 offen sc1 lds
    s_add_u32 m0, s83, 0
    s_nop 0
    buffer_load_dwordx4 v10, s[36:39], s76 offen offset:1024 sc1 lds
    s_add_u32 m0, s83, 0
    s_nop 0
    buffer_load_dwordx4 v10, s[36:39], s76 offen offset:2048 sc1 lds
    s_mov_b32 exec_hi, 0
    s_add_u32 m0, s83, 0
    s_nop 0
    buffer_load_dwordx4 v10, s[36:39], s76 offen offset:3072 sc1 lds
    s_mov_b32 exec_hi, -1
    s_add_u32 s83, s83, 14336
    s_cmp_ge_u32 s83, 151552
    s_cselect_b32 s92, 86016, 0
    s_sub_u32 s83, s83, s92
    s_lshr_b32 s76, s47, 1
    s_and_b32 s76, s76, 6
    s_lshr_b32 s92, s47, 4
    s_add_u32 s76, s76, s92
    s_lshl_b32 s76, s76, 18
    s_and_b32 s92, s47, 3
    s_mul_i32 s92, s92, 65536
    s_add_u32 s76, s76, s92
    s_add_u32 s47, s47, 1
    s_add_u32 s76, s76, s84
    s_add_u32 m0, s34, 0
    s_nop 0
    buffer_load_dwordx4 v13, s[4:7], s76 offen  lds
    s_add_u32 m0, s34, 896
    s_nop 0
    buffer_load_dwordx4 v13, s[4:7], s76 offen offset:128  lds
    s_add_u32 s34, s34, 8192
    s_and_b32 s34, s34, 65535
    s_waitcnt vmcnt(27)
    s_barrier
    s_sub_u32 s72, s72, 1
    s_cmp_lg_u32 s72, 0
    s_cbranch_scc1 H_L0
    s_lshr_b32 s76, s73, 1
    s_and_b32 s76, s76, 6
    s_lshr_b32 s92, s73, 4
    s_add_u32 s76, s76, s92
    s_lshl_b32 s76, s76, 16
    s_and_b32 s92, s73, 3
    s_mul_i32 s92, s92, 14336
    s_add_u32 s76, s76, s92
    s_add_u32 s73, s73, 1
    s_add_u32 s76, s76, s85
    s_add_u32 m0, s83, 0
    s_nop 0
    buffer_load_dwordx4 v10, s[36:39], s76 offen sc1 lds
    s_add_u32 m0, s83, 0
    s_nop 0
    buffer_load_dwordx4 v10, s[36:39], s76 offen offset:1024 sc1 lds
    s_add_u32 m0, s83, 0
    s_nop 0
    buffer_load_dwordx4 v10, s[36:39], s76 offen offset:2048 sc1 lds
    s_mov_b32 exec_hi, 0
    s_add_u32 m0, s83, 0
    s_nop 0
    buffer_load_dwordx4 v10, s[36:39], s76 offen offset:3072 sc1 lds
    s_mov_b32 exec_hi, -1
    s_add_u32 s83, s83, 14336
    s_cmp_ge_u32 s83, 151552
    s_cselect_b32 s92, 86016, 0
    s_sub_u32 s83, s83, s92
    s_lshr_b32 s76, s47, 1
    s_and_b32 s76, s76, 6
    s_lshr_b32 s92, s47, 4
    s_add_u32 s76, s76, s92
    s_lshl_b32 s76, s76, 18
    s_and_b32 s92, s47, 3
    s_mul_i32 s92, s92, 65536
    s_add_u32 s76, s76, s92
    s_add_u32 s47, s47, 1
    s_add_u32 s76, s76, s84
    s_add_u32 m0, s34, 0
    s_nop 0
    buffer_load_dwordx4 v13, s[4:7], s76 offen  lds
    s_add_u32 m0, s34, 896
    s_nop 0
    buffer_load_dwordx4 v13, s[4:7], s76 offen offset:128  lds
    s_add_u32 s34, s34, 8192
    s_and_b32 s34, s34, 65535
    s_waitcnt vmcnt(24)
    s_cmp_lg_u32 s82, 3
    s_cbranch_scc1 POLLED1
    s_mov_b32 s76, 0x40000
POLL1:
    v_cmp_eq_u64 vcc, v[242:243], v[240:241]
    s_or_b64 vcc, vcc, s[90:91]
    s_cmp_eq_u64 vcc, -1
    s_cbranch_scc1 POLLED1
    s_sleep 4
    buffer_load_dwordx2 v[242:243], v6, s[56:59], s93 offen offset:128 sc0 sc1
    s_waitcnt vmcnt(0)
    s_sub_u32 s76, s76, 1
    s_cbranch_scc0 POLL1
POLLED1:
    s_barrier
    s_mov_b32 s72, 14
H_L1:
    s_lshr_b32 s76, s73, 1
    s_and_b32 s76, s76, 6
    s_lshr_b32 s92, s73, 4
    s_add_u32 s76, s76, s92
    s_lshl_b32 s76, s76, 16
    s_and_b32 s92, s73, 3
    s_mul_i32 s92, s92, 14336
    s_add_u32 s76, s76, s92
    s_add_u32 s73, s73, 1
    s_add_u32 s76, s76, s85
    s_add_u32 m0, s83, 0
    s_nop 0
    buffer_load_dwordx4 v10, s[36:39], s76 offen sc1 lds
    s_add_u32 m0, s83, 0
    s_nop 0
    buffer_load_dwordx4 v10, s[36:39], s76 offen offset:1024 sc1 lds
    s_add_u32 m0, s83, 0
    s_nop 0
    buffer_load_dwordx4 v10, s[36:39], s76 offen offset:2048 sc1 lds
    s_mov_b32 exec_hi, 0
    s_add_u32 m0, s83, 0
    s_nop 0
    buffer_load_dwordx4 v10, s[36:39], s76 offen offset:3072 sc1 lds
    s_mov_b32 exec_hi, -1
    s_add_u32 s83, s83, 14336
    s_cmp_ge_u32 s83, 151552
    s_cselect_b32 s92, 86016, 0
    s_sub_u32 s83, s83, s92
    s_lshr_b32 s76, s47, 1
    s_and_b32 s76, s76, 6
    s_lshr_b32 s92, s47, 4
    s_add_u32 s76, s76, s92
    s_lshl_b32 s76, s76, 18
    s_and_b32 s92, s47, 3
    s_mul_i32 s92, s92, 65536
    s_add_u32 s76, s76, s92
    s_add_u32 s47, s47, 1
    s_add_u32 s76, s76, s84
    s_add_u32 m0, s34, 0
    s_nop 0
    buffer_load_dwordx4 v13, s[4:7], s76 offen  lds
    s_add_u32 m0, s34, 896
    s_nop 0
    buffer_load_dwordx4 v13, s[4:7], s76 offen offset:128  lds
    s_add_u32 s34, s34, 8192
    s_and_b32 s34, s34, 65535
    s_waitcnt vmcnt(26)
    s_barrier
    s_sub_u32 s72, s72, 1
    s_cmp_lg_u32 s72, 0
    s_cbranch_scc1 H_L1
    s_lshr_b32 s76, s73, 1
    s_and_b32 s76, s76, 6
    s_lshr_b32 s92, s73, 4
    s_add_u32 s76, s76, s92
    s_lshl_b32 s76, s76, 16
    s_and_b32 s92, s73, 3
    s_mul_i32 s92, s92, 14336
    s_add_u32 s76, s76, s92
    s_add_u32 s73, s73, 1
    s_add_u32 s76, s76, s85
    s_add_u32 m0, s83, 0
    s_nop 0
    buffer_load_dwordx4 v10, s[36:39], s76 offen sc1 lds
    s_add_u32 m0, s83, 0
    s_nop 0
    buffer_load_dwordx4 v10, s[36:39], s76 offen offset:1024 sc1 lds
    s_add_u32 m0, s83, 0
    s_nop 0
    buffer_load_dwordx4 v10, s[36:39], s76 offen offset:2048 sc1 lds
    s_mov_b32 exec_hi, 0
    s_add_u32 m0, s83, 0
    s_nop 0
    buffer_load_dwordx4 v10, s[36:39], s76 offen offset:3072 sc1 lds
    s_mov_b32 exec_hi, -1
    s_add_u32 s83, s83, 14336
    s_cmp_ge_u32 s83, 151552
    s_cselect_b32 s92, 86016, 0
    s_sub_u32 s83, s83, s92
    s_waitcnt vmcnt(24)
    s_barrier
    s_lshr_b32 s76, s73, 1
    s_and_b32 s76, s76, 6
    s_lshr_b32 s92, s73, 4
    s_add_u32 s76, s76, s92
    s_lshl_b32 s76, s76, 16
    s_and_b32 s92, s73, 3
    s_mul_i32 s92, s92, 14336
    s_add_u32 s76, s76, s92
    s_add_u32 s73, s73, 1
    s_add_u32 s76, s76, s85
    s_add_u32 m0, s83, 0
    s_nop 0
    buffer_load_dwordx4 v10, s[36:39], s76 offen sc1 lds
    s_add_u32 m0, s83, 0
    s_nop 0
    buffer_load_dwordx4 v10, s[36:39], s76 offen offset:1024 sc1 lds
    s_add_u32 m0, s83, 0
    s_nop 0
    buffer_load_dwordx4 v10, s[36:39], s76 offen offset:2048 sc1 lds
    s_mov_b32 exec_hi, 0
    s_add_u32 m0, s83, 0
    s_nop 0
    buffer_load_dwordx4 v10, s[36:39], s76 offen offset:3072 sc1 lds
    s_mov_b32 exec_hi, -1
    s_add_u32 s83, s83, 14336
    s_cmp_ge_u32 s83, 151552
    s_cselect_b32 s92, 86016, 0
    s_sub_u32 s83, s83, s92
    s_waitcnt vmcnt(22)
    s_barrier
    s_waitcnt vmcnt(16)
    s_barrier
    s_waitcnt vmcnt(10)
    s_barrier
    s_waitcnt vmcnt(4)
    s_barrier
    s_waitcnt vmcnt(0)
    s_barrier
    s_endpgm
K_COMP:
    s_lshl_b32 s76, s46, 8
    s_lshl_b32 s77, s40, 11
    s_add_u32 s77, s77, s76
    s_sub_u32 s92, 917504, s77
    s_mul_i32 s76, s45, 917504
    s_add_u32 s77, s77, s76
    s_add_u32 s68, s28, s77
    s_addc_u32 s69, s29, 0
    s_and_b32 s69, s69, 0xffff
    s_mov_b32 s70, s92
    s_mov_b32 s71, 0x20000
    s_lshl_b32 s76, s40, 2
    s_add_u32 s76, s76, s45
    s_lshl_b32 s76, s76, 3
    s_add_u32 s76, s76, s46
    s_lshl_b32 s77, s76, 18
    s_add_u32 s77, s77, 33554432
    s_add_u32 s48, s32, s77
    s_addc_u32 s49, s33, 0
    s_and_b32 s49, s49, 0xffff
    s_mov_b32 s50, 262144
    s_mov_b32 s51, 0x20000
    s_lshl_b32 s77, s76, 9
    s_add_u32 s77, s77, 25231360
    s_add_u32 s52, s32, s77
    s_addc_u32 s53, s33, 0
    s_and_b32 s53, s53, 0xffff
    s_mov_b32 s54, 512
    s_mov_b32 s55, 0x20000
    v_and_b32 v2, 15, v1
    v_lshrrev_b32 v3, 4, v1
    v_bfe_u32 v4, v1, 3, 1
    v_lshlrev_b32 v8, 11, v4
    v_and_b32 v4, 7, v1
    v_lshl_add_u32 v8, v4, 7, v8
    v_bfe_u32 v4, v1, 1, 3
    v_xor_b32 v4, v4, v3
    v_lshl_add_u32 v8, v4, 4, v8
    v_xor_b32 v9, 64, v8
    v_lshrrev_b32 v5, 5, v1
    v_lshlrev_b32 v10, 11, v5
    v_bfe_u32 v6, v1, 4, 1
    v_lshl_add_u32 v10, v6, 9, v10
    v_lshl_add_u32 v10, v6, 5, v10
    v_bfe_u32 v4, v1, 2, 2
    v_lshl_add_u32 v10, v4, 7, v10
    v_bfe_u32 v4, v1, 3, 1
    v_lshl_add_u32 v10, v4, 6, v10
    v_and_b32 v4, 3, v1
    v_lshl_add_u32 v10, v4, 3, v10
    v_add_u32 v10, 147456, v10
    v_xor_b32 v11, 32, v10
    v_xor_b32 v12, 64, v10
    v_xor_b32 v13, 96, v10
    s_mov_b32 s75, 131072
    s_mov_b32 s74, 0
    s_mov_b32 s78, 0x4b800000
    s_mov_b32 s73, 0
    s_mov_b32 s47, 163840
    v_lshlrev_b32 v2, 4, v2
    v_lshl_add_u32 v2, v5, 8, v2
    v_and_b32 v4, 15, v1
    v_lshlrev_b32 v4, 4, v4
    v_lshl_add_u32 v4, v6, 8, v4
    v_mul_u32_u24 v7, 7168, v5
    v_add_u32 v4, v4, v7
    v_add_u32 v252, 65536, v4
    v_lshlrev_b32 v253, 11, v3
    v_bfe_u32 v4, v1, 2, 2
    v_lshl_add_u32 v253, v4, 7, v253
    v_bfe_u32 v4, v1, 3, 1
    v_lshl_add_u32 v253, v4, 6, v253
    v_lshl_add_u32 v253, v6, 5, v253
    v_and_b32 v4, 3, v1
    v_lshl_add_u32 v253, v4, 3, v253
    s_and_b32 s76, s3, 1
    s_lshl_b32 s76, s76, 6
    v_xor_b32 v253, s76, v253
    s_lshr_b32 s76, s3, 1
    s_lshl_b32 s76, s76, 10
    v_add_u32 v253, s76, v253
    v_mul_u32_u24 v6, 7168, v6
    s_and_b32 s76, s42, 1
    s_mul_i32 s76, s76, 3584
    s_lshl_b32 s77, s3, 10
    s_add_u32 s76, s76, s77
    v_add3_u32 v14, v2, v6, s76
    v_bfe_u32 v2, v1, 2, 2
    v_lshlrev_b32 v60, 7, v2
    v_bfe_u32 v3, v1, 3, 1
    v_lshl_add_u32 v60, v3, 6, v60
    v_bfe_u32 v3, v1, 4, 1
    v_lshl_add_u32 v60, v3, 5, v60
    v_and_b32 v3, 3, v1
    v_lshl_add_u32 v60, v3, 3, v60
    v_lshrrev_b32 v4, 4, v1
    v_lshl_add_u32 v60, v4, 12, v60
    s_lshl_b32 s76, s3, 10
    s_add_u32 s76, s76, 32768
    v_add_u32 v60, s76, v60
    v_xor_b32 v61, 32, v60
    v_xor_b32 v62, 64, v60
    v_xor_b32 v63, 96, v60
    v_and_b32 v2, 15, v1
    v_lshlrev_b32 v64, 7, v2
    v_bfe_u32 v3, v1, 1, 3
    v_xor_b32 v3, v3, v4
    v_lshl_add_u32 v64, v3, 4, v64
    v_add_u32 v64, 114688, v64
    v_xor_b32 v65, 64, v64
    s_mov_b32 s72, 15
    s_mov_b32 s86, 0
    s_mov_b32 s87, 0
    s_waitcnt lgkmcnt(0)
    s_barrier
    ds_read_b64_tr_b16 v[16:17], v60 offset:0
    ds_read_b64_tr_b16 v[18:19], v60 offset:512
    ds_read_b64_tr_b16 v[20:21], v61 offset:0
    ds_read_b64_tr_b16 v[22:23], v61 offset:512
    ds_read_b64_tr_b16 v[24:25], v62 offset:0
    ds_read_b64_tr_b16 v[26:27], v62 offset:512
    ds_read_b64_tr_b16 v[28:29], v63 offset:0
    ds_read_b64_tr_b16 v[30:31], v63 offset:512
    ds_read_b128 v[32:35], v64 offset:0
    ds_read_b128 v[36:39], v64 offset:2048
    ds_read_b128 v[40:43], v64 offset:4096
    ds_read_b128 v[44:47], v64 offset:6144
    ds_read_b128 v[48:51], v64 offset:8192
    ds_read_b128 v[52:55], v64 offset:10240
    ds_read_b128 v[56:59], v64 offset:12288
    s_add_u32 s86, s86, 1
    s_cmp_eq_u32 s86, 5
    s_mov_b32 s92, 16384
    s_cselect_b32 s92, 4294901760, s92
    s_cselect_b32 s86, 0, s86
    v_add_u32 v60, s92, v60
    v_add_u32 v61, s92, v61
    v_add_u32 v62, s92, v62
    v_add_u32 v63, s92, v63
    s_waitcnt lgkmcnt(6)
    v_mfma_f32_16x16x32_bf16 v[96:99], v[16:19], v[32:35], 0
    v_mfma_f32_16x16x32_bf16 v[124:127], v[20:23], v[32:35], 0
    v_mfma_f32_16x16x32_bf16 v[152:155], v[24:27], v[32:35], 0
    v_mfma_f32_16x16x32_bf16 v[180:183], v[28:31], v[32:35], 0
    s_waitcnt lgkmcnt(5)
    v_mfma_f32_16x16x32_bf16 v[100:103], v[16:19], v[36:39], 0
    v_mfma_f32_16x16x32_bf16 v[128:131], v[20:23], v[36:39], 0
    v_mfma_f32_16x16x32_bf16 v[156:159], v[24:27], v[36:39], 0
    v_mfma_f32_16x16x32_bf16 v[184:187], v[28:31], v[36:39], 0
    s_waitcnt lgkmcnt(4)
    v_mfma_f32_16x16x32_bf16 v[104:107], v[16:19], v[40:43], 0
    s_waitcnt lgkmcnt(0)
    s_barrier
    ds_read_b64_tr_b16 v[208:209], v60 offset:0
    v_mfma_f32_16x16x32_bf16 v[132:135], v[20:23], v[40:43], 0
    ds_read_b64_tr_b16 v[210:211], v60 offset:512
    v_mfma_f32_16x16x32_bf16 v[160:163], v[24:27], v[40:43], 0
    ds_read_b64_tr_b16 v[212:213], v61 offset:0
    v_mfma_f32_16x16x32_bf16 v[188:191], v[28:31], v[40:43], 0
    ds_read_b64_tr_b16 v[214:215], v61 offset:512
    v_mfma_f32_16x16x32_bf16 v[108:111], v[16:19], v[44:47], 0
    ds_read_b64_tr_b16 v[216:217], v62 offset:0
    v_mfma_f32_16x16x32_bf16 v[136:139], v[20:23], v[44:47], 0
    ds_read_b64_tr_b16 v[218:219], v62 offset:512
    v_mfma_f32_16x16x32_bf16 v[164:167], v[24:27], v[44:47], 0
    ds_read_b64_tr_b16 v[220:221], v63 offset:0
    v_mfma_f32_16x16x32_bf16 v[192:195], v[28:31], v[44:47], 0
    ds_read_b64_tr_b16 v[222:223], v63 offset:512
    v_mfma_f32_16x16x32_bf16 v[112:115], v[16:19], v[48:51], 0
    ds_read_b128 v[224:227], v65 offset:0
    v_mfma_f32_16x16x32_bf16 v[140:143], v[20:23], v[48:51], 0
    ds_read_b128 v[228:231], v65 offset:2048
    v_mfma_f32_16x16x32_bf16 v[168:171], v[24:27], v[48:51], 0
    ds_read_b128 v[232:235], v65 offset:4096
    v_mfma_f32_16x16x32_bf16 v[196:199], v[28:31], v[48:51], 0
    ds_read_b128 v[236:239], v65 offset:6144
    v_mfma_f32_16x16x32_bf16 v[116:119], v[16:19], v[52:55], 0
    ds_read_b128 v[240:243], v65 offset:8192
    v_mfma_f32_16x16x32_bf16 v[144:147], v[20:23], v[52:55], 0
    ds_read_b128 v[244:247], v65 offset:10240
    v_mfma_f32_16x16x32_bf16 v[172:175], v[24:27], v[52:55], 0
    ds_read_b128 v[248:251], v65 offset:12288
    v_mfma_f32_16x16x32_bf16 v[200:203], v[28:31], v[52:55], 0
    s_add_u32 s86, s86, 1
    s_cmp_eq_u32 s86, 5
    v_mfma_f32_16x16x32_bf16 v[120:123], v[16:19], v[56:59], 0
    s_mov_b32 s92, 16384
    s_cselect_b32 s92, 4294901760, s92
    v_mfma_f32_16x16x32_bf16 v[148:151], v[20:23], v[56:59], 0
    s_cselect_b32 s86, 0, s86
    v_add_u32 v60, s92, v60
    v_mfma_f32_16x16x32_bf16 v[176:179], v[24:27], v[56:59], 0
    v_add_u32 v61, s92, v61
    v_add_u32 v62, s92, v62
    v_mfma_f32_16x16x32_bf16 v[204:207], v[28:31], v[56:59], 0
    v_add_u32 v63, s92, v63
P0_LOOP:
    s_waitcnt lgkmcnt(6)
    v_mfma_f32_16x16x32_bf16 v[96:99], v[208:211], v[224:227], v[96:99]
    s_add_u32 s87, s87, 1
    v_mfma_f32_16x16x32_bf16 v[124:127], v[212:215], v[224:227], v[124:127]
    s_cmp_eq_u32 s87, 3
    v_mfma_f32_16x16x32_bf16 v[152:155], v[216:219], v[224:227], v[152:155]
    s_mov_b32 s79, 16384
    v_mfma_f32_16x16x32_bf16 v[180:183], v[220:223], v[224:227], v[180:183]
    s_cselect_b32 s79, 4294934528, s79
    s_waitcnt lgkmcnt(5)
    v_mfma_f32_16x16x32_bf16 v[100:103], v[208:211], v[228:231], v[100:103]
    s_cselect_b32 s87, 0, s87
    v_mfma_f32_16x16x32_bf16 v[128:131], v[212:215], v[228:231], v[128:131]
    v_add_u32 v64, s79, v64
    v_mfma_f32_16x16x32_bf16 v[156:159], v[216:219], v[228:231], v[156:159]
    v_add_u32 v65, s79, v65
    v_mfma_f32_16x16x32_bf16 v[184:187], v[220:223], v[228:231], v[184:187]
    s_waitcnt lgkmcnt(4)
    v_mfma_f32_16x16x32_bf16 v[104:107], v[208:211], v[232:235], v[104:107]
    s_waitcnt lgkmcnt(0)
    s_barrier
    ds_read_b64_tr_b16 v[16:17], v60 offset:0
    v_mfma_f32_16x16x32_bf16 v[132:135], v[212:215], v[232:235], v[132:135]
    ds_read_b64_tr_b16 v[18:19], v60 offset:512
    v_mfma_f32_16x16x32_bf16 v[160:163], v[216:219], v[232:235], v[160:163]
    ds_read_b64_tr_b16 v[20:21], v61 offset:0
    v_mfma_f32_16x16x32_bf16 v[188:191], v[220:223], v[232:235], v[188:191]
    ds_read_b64_tr_b16 v[22:23], v61 offset:512
    v_mfma_f32_16x16x32_bf16 v[108:111], v[208:211], v[236:239], v[108:111]
    ds_read_b64_tr_b16 v[24:25], v62 offset:0
    v_mfma_f32_16x16x32_bf16 v[136:139], v[212:215], v[236:239], v[136:139]
    ds_read_b64_tr_b16 v[26:27], v62 offset:512
    v_mfma_f32_16x16x32_bf16 v[164:167], v[216:219], v[236:239], v[164:167]
    ds_read_b64_tr_b16 v[28:29], v63 offset:0
    v_mfma_f32_16x16x32_bf16 v[192:195], v[220:223], v[236:239], v[192:195]
    ds_read_b64_tr_b16 v[30:31], v63 offset:512
    v_mfma_f32_16x16x32_bf16 v[112:115], v[208:211], v[240:243], v[112:115]
    ds_read_b128 v[32:35], v64 offset:0
    v_mfma_f32_16x16x32_bf16 v[140:143], v[212:215], v[240:243], v[140:143]
    ds_read_b128 v[36:39], v64 offset:2048
    v_mfma_f32_16x16x32_bf16 v[168:171], v[216:219], v[240:243], v[168:171]
    ds_read_b128 v[40:43], v64 offset:4096
    v_mfma_f32_16x16x32_bf16 v[196:199], v[220:223], v[240:243], v[196:199]
    ds_read_b128 v[44:47], v64 offset:6144
    v_mfma_f32_16x16x32_bf16 v[116:119], v[208:211], v[244:247], v[116:119]
    ds_read_b128 v[48:51], v64 offset:8192
    v_mfma_f32_16x16x32_bf16 v[144:147], v[212:215], v[244:247], v[144:147]
    ds_read_b128 v[52:55], v64 offset:10240
    v_mfma_f32_16x16x32_bf16 v[172:175], v[216:219], v[244:247], v[172:175]
    ds_read_b128 v[56:59], v64 offset:12288
    v_mfma_f32_16x16x32_bf16 v[200:203], v[220:223], v[244:247], v[200:203]
    s_add_u32 s86, s86, 1
    s_cmp_eq_u32 s86, 5
    v_mfma_f32_16x16x32_bf16 v[120:123], v[208:211], v[248:251], v[120:123]
    s_mov_b32 s92, 16384
    s_cselect_b32 s92, 4294901760, s92
    v_mfma_f32_16x16x32_bf16 v[148:151], v[212:215], v[248:251], v[148:151]
    s_cselect_b32 s86, 0, s86
    v_add_u32 v60, s92, v60
    v_mfma_f32_16x16x32_bf16 v[176:179], v[216:219], v[248:251], v[176:179]
    v_add_u32 v61, s92, v61
    v_add_u32 v62, s92, v62
    v_mfma_f32_16x16x32_bf16 v[204:207], v[220:223], v[248:251], v[204:207]
    v_add_u32 v63, s92, v63
    s_waitcnt lgkmcnt(6)
    v_mfma_f32_16x16x32_bf16 v[96:99], v[16:19], v[32:35], v[96:99]
    v_mfma_f32_16x16x32_bf16 v[124:127], v[20:23], v[32:35], v[124:127]
    v_mfma_f32_16x16x32_bf16 v[152:155], v[24:27], v[32:35], v[152:155]
    v_mfma_f32_16x16x32_bf16 v[180:183], v[28:31], v[32:35], v[180:183]
    s_waitcnt lgkmcnt(5)
    v_mfma_f32_16x16x32_bf16 v[100:103], v[16:19], v[36:39], v[100:103]
    v_mfma_f32_16x16x32_bf16 v[128:131], v[20:23], v[36:39], v[128:131]
    v_mfma_f32_16x16x32_bf16 v[156:159], v[24:27], v[36:39], v[156:159]
    v_mfma_f32_16x16x32_bf16 v[184:187], v[28:31], v[36:39], v[184:187]
    s_waitcnt lgkmcnt(4)
    v_mfma_f32_16x16x32_bf16 v[104:107], v[16:19], v[40:43], v[104:107]
    s_waitcnt lgkmcnt(0)
    s_barrier
    ds_read_b64_tr_b16 v[208:209], v60 offset:0
    v_mfma_f32_16x16x32_bf16 v[132:135], v[20:23], v[40:43], v[132:135]
    ds_read_b64_tr_b16 v[210:211], v60 offset:512
    v_mfma_f32_16x16x32_bf16 v[160:163], v[24:27], v[40:43], v[160:163]
    ds_read_b64_tr_b16 v[212:213], v61 offset:0
    v_mfma_f32_16x16x32_bf16 v[188:191], v[28:31], v[40:43], v[188:191]
    ds_read_b64_tr_b16 v[214:215], v61 offset:512
    v_mfma_f32_16x16x32_bf16 v[108:111], v[16:19], v[44:47], v[108:111]
    ds_read_b64_tr_b16 v[216:217], v62 offset:0
    v_mfma_f32_16x16x32_bf16 v[136:139], v[20:23], v[44:47], v[136:139]
    ds_read_b64_tr_b16 v[218:219], v62 offset:512
    v_mfma_f32_16x16x32_bf16 v[164:167], v[24:27], v[44:47], v[164:167]
    ds_read_b64_tr_b16 v[220:221], v63 offset:0
    v_mfma_f32_16x16x32_bf16 v[192:195], v[28:31], v[44:47], v[192:195]
    ds_read_b64_tr_b16 v[222:223], v63 offset:512
    v_mfma_f32_16x16x32_bf16 v[112:115], v[16:19], v[48:51], v[112:115]
    ds_read_b128 v[224:227], v65 offset:0
    v_mfma_f32_16x16x32_bf16 v[140:143], v[20:23], v[48:51], v[140:143]
    ds_read_b128 v[228:231], v65 offset:2048
    v_mfma_f32_16x16x32_bf16 v[168:171], v[24:27], v[48:51], v[168:171]
    ds_read_b128 v[232:235], v65 offset:4096
    v_mfma_f32_16x16x32_bf16 v[196:199], v[28:31], v[48:51], v[196:199]
    ds_read_b128 v[236:239], v65 offset:6144
    v_mfma_f32_16x16x32_bf16 v[116:119], v[16:19], v[52:55], v[116:119]
    ds_read_b128 v[240:243], v65 offset:8192
    v_mfma_f32_16x16x32_bf16 v[144:147], v[20:23], v[52:55], v[144:147]
    ds_read_b128 v[244:247], v65 offset:10240
    v_mfma_f32_16x16x32_bf16 v[172:175], v[24:27], v[52:55], v[172:175]
    ds_read_b128 v[248:251], v65 offset:12288
    v_mfma_f32_16x16x32_bf16 v[200:203], v[28:31], v[52:55], v[200:203]
    s_add_u32 s86, s86, 1
    s_cmp_eq_u32 s86, 5
    s_mov_b32 s92, 16384
    v_mfma_f32_16x16x32_bf16 v[120:123], v[16:19], v[56:59], v[120:123]
    s_cselect_b32 s92, 4294901760, s92
    s_cselect_b32 s86, 0, s86
    v_mfma_f32_16x16x32_bf16 v[148:151], v[20:23], v[56:59], v[148:151]
    v_add_u32 v60, s92, v60
    v_add_u32 v61, s92, v61
    v_mfma_f32_16x16x32_bf16 v[176:179], v[24:27], v[56:59], v[176:179]
    v_add_u32 v62, s92, v62
    v_add_u32 v63, s92, v63
    v_mfma_f32_16x16x32_bf16 v[204:207], v[28:31], v[56:59], v[204:207]
    s_sub_u32 s72, s72, 1
    s_cmp_lg_u32 s72, 0
    s_cbranch_scc1 P0_LOOP
    s_waitcnt lgkmcnt(6)
    v_mfma_f32_16x16x32_bf16 v[96:99], v[208:211], v[224:227], v[96:99]
    v_mfma_f32_16x16x32_bf16 v[124:127], v[212:215], v[224:227], v[124:127]
    v_mfma_f32_16x16x32_bf16 v[152:155], v[216:219], v[224:227], v[152:155]
    v_mfma_f32_16x16x32_bf16 v[180:183], v[220:223], v[224:227], v[180:183]
    s_waitcnt lgkmcnt(5)
    v_mfma_f32_16x16x32_bf16 v[100:103], v[208:211], v[228:231], v[100:103]
    v_mfma_f32_16x16x32_bf16 v[128:131], v[212:215], v[228:231], v[128:131]
    v_mfma_f32_16x16x32_bf16 v[156:159], v[216:219], v[228:231], v[156:159]
    v_mfma_f32_16x16x32_bf16 v[184:187], v[220:223], v[228:231], v[184:187]
    s_waitcnt lgkmcnt(4)
    v_mfma_f32_16x16x32_bf16 v[104:107], v[208:211], v[232:235], v[104:107]
    v_mfma_f32_16x16x32_bf16 v[132:135], v[212:215], v[232:235], v[132:135]
    v_mfma_f32_16x16x32_bf16 v[160:163], v[216:219], v[232:235], v[160:163]
    v_mfma_f32_16x16x32_bf16 v[188:191], v[220:223], v[232:235], v[188:191]
    s_waitcnt lgkmcnt(3)
    v_mfma_f32_16x16x32_bf16 v[108:111], v[208:211], v[236:239], v[108:111]
    v_mfma_f32_16x16x32_bf16 v[136:139], v[212:215], v[236:239], v[136:139]
    v_mfma_f32_16x16x32_bf16 v[164:167], v[216:219], v[236:239], v[164:167]
    v_mfma_f32_16x16x32_bf16 v[192:195], v[220:223], v[236:239], v[192:195]
    s_waitcnt lgkmcnt(2)
    v_mfma_f32_16x16x32_bf16 v[112:115], v[208:211], v[240:243], v[112:115]
    v_mfma_f32_16x16x32_bf16 v[140:143], v[212:215], v[240:243], v[140:143]
    v_mfma_f32_16x16x32_bf16 v[168:171], v[216:219], v[240:243], v[168:171]
    v_mfma_f32_16x16x32_bf16 v[196:199], v[220:223], v[240:243], v[196:199]
    s_waitcnt lgkmcnt(1)
    v_mfma_f32_16x16x32_bf16 v[116:119], v[208:211], v[244:247], v[116:119]
    v_mfma_f32_16x16x32_bf16 v[144:147], v[212:215], v[244:247], v[144:147]
    v_mfma_f32_16x16x32_bf16 v[172:175], v[216:219], v[244:247], v[172:175]
    v_mfma_f32_16x16x32_bf16 v[200:203], v[220:223], v[244:247], v[200:203]
    s_waitcnt lgkmcnt(0)
    v_mfma_f32_16x16x32_bf16 v[120:123], v[208:211], v[248:251], v[120:123]
    v_mfma_f32_16x16x32_bf16 v[148:151], v[212:215], v[248:251], v[148:151]
    v_mfma_f32_16x16x32_bf16 v[176:179], v[216:219], v[248:251], v[176:179]
    v_mfma_f32_16x16x32_bf16 v[204:207], v[220:223], v[248:251], v[204:207]
    s_mov_b32 s4, 0x3e0293ee
    s_mov_b32 s5, 0x3e0293ee
    v_and_b32 v2, 15, v1
    v_lshlrev_b32 v2, 4, v2
    v_lshrrev_b32 v3, 5, v1
    v_lshl_add_u32 v2, v3, 8, v2
    v_bfe_u32 v3, v1, 4, 1
    v_and_b32 v4, 15, v1
    v_lshlrev_b32 v4, 4, v4
    v_lshl_add_u32 v4, v3, 8, v4
    v_lshrrev_b32 v5, 5, v1
    v_lshl_add_u32 v4, v5, 12, v4
    v_lshl_add_u32 v2, v3, 3, v2
    s_lshr_b32 s76, s3, 1
    s_lshl_b32 s76, s76, 16
    s_and_b32 s77, s3, 1
    s_lshl_b32 s77, s77, 14
    s_add_u32 s76, s76, s77
    s_add_u32 s76, s76, 65536
    v_add_u32 v2, s76, v2
    s_lshl_b32 s76, s3, 10
    s_add_u32 s76, s76, 65536
    v_add_u32 v4, s76, v4
    v_add_u32 v5, 65536, v4
    v_pk_mul_f32 v[96:97], v[96:97], s[4:5]
    v_pk_mul_f32 v[98:99], v[98:99], s[4:5]
    v_cvt_pk_bf16_f32 v16, v96, v97
    v_cvt_pk_bf16_f32 v17, v98, v99
    ds_write_b64 v2, v[16:17] offset:0
    v_pk_mul_f32 v[124:125], v[124:125], s[4:5]
    v_pk_mul_f32 v[126:127], v[126:127], s[4:5]
    v_cvt_pk_bf16_f32 v18, v124, v125
    v_cvt_pk_bf16_f32 v19, v126, v127
    ds_write_b64 v2, v[18:19] offset:4096
    v_pk_mul_f32 v[152:153], v[152:153], s[4:5]
    v_pk_mul_f32 v[154:155], v[154:155], s[4:5]
    v_cvt_pk_bf16_f32 v20, v152, v153
    v_cvt_pk_bf16_f32 v21, v154, v155
    ds_write_b64 v2, v[20:21] offset:8192
    v_pk_mul_f32 v[180:181], v[180:181], s[4:5]
    v_pk_mul_f32 v[182:183], v[182:183], s[4:5]
    v_cvt_pk_bf16_f32 v22, v180, v181
    v_cvt_pk_bf16_f32 v23, v182, v183
    ds_write_b64 v2, v[22:23] offset:12288
    v_pk_mul_f32 v[100:101], v[100:101], s[4:5]
    v_pk_mul_f32 v[102:103], v[102:103], s[4:5]
    v_cvt_pk_bf16_f32 v24, v100, v101
    v_cvt_pk_bf16_f32 v25, v102, v103
    ds_write_b64 v2, v[24:25] offset:512
    v_pk_mul_f32 v[128:129], v[128:129], s[4:5]
    v_pk_mul_f32 v[130:131], v[130:131], s[4:5]
    v_cvt_pk_bf16_f32 v26, v128, v129
    v_cvt_pk_bf16_f32 v27, v130, v131
    ds_write_b64 v2, v[26:27] offset:4608
    v_pk_mul_f32 v[156:157], v[156:157], s[4:5]
    v_pk_mul_f32 v[158:159], v[158:159], s[4:5]
    v_cvt_pk_bf16_f32 v28, v156, v157
    v_cvt_pk_bf16_f32 v29, v158, v159
    ds_write_b64 v2, v[28:29] offset:8704
    v_pk_mul_f32 v[184:185], v[184:185], s[4:5]
    v_pk_mul_f32 v[186:187], v[186:187], s[4:5]
    v_cvt_pk_bf16_f32 v30, v184, v185
    v_cvt_pk_bf16_f32 v31, v186, v187
    ds_write_b64 v2, v[30:31] offset:12800
    s_waitcnt lgkmcnt(7)
    v_pk_mul_f32 v[104:105], v[104:105], s[4:5]
    v_pk_mul_f32 v[106:107], v[106:107], s[4:5]
    v_cvt_pk_bf16_f32 v32, v104, v105
    v_cvt_pk_bf16_f32 v33, v106, v107
    ds_write_b64 v2, v[32:33] offset:1024
    v_pk_mul_f32 v[132:133], v[132:133], s[4:5]
    v_pk_mul_f32 v[134:135], v[134:135], s[4:5]
    v_cvt_pk_bf16_f32 v34, v132, v133
    v_cvt_pk_bf16_f32 v35, v134, v135
    ds_write_b64 v2, v[34:35] offset:5120
    v_pk_mul_f32 v[160:161], v[160:161], s[4:5]
    v_pk_mul_f32 v[162:163], v[162:163], s[4:5]
    v_cvt_pk_bf16_f32 v36, v160, v161
    v_cvt_pk_bf16_f32 v37, v162, v163
    ds_write_b64 v2, v[36:37] offset:9216
    v_pk_mul_f32 v[188:189], v[188:189], s[4:5]
    v_pk_mul_f32 v[190:191], v[190:191], s[4:5]
    v_cvt_pk_bf16_f32 v38, v188, v189
    v_cvt_pk_bf16_f32 v39, v190, v191
    ds_write_b64 v2, v[38:39] offset:13312
    v_pk_mul_f32 v[108:109], v[108:109], s[4:5]
    v_pk_mul_f32 v[110:111], v[110:111], s[4:5]
    v_cvt_pk_bf16_f32 v40, v108, v109
    v_cvt_pk_bf16_f32 v41, v110, v111
    ds_write_b64 v2, v[40:41] offset:1536
    v_pk_mul_f32 v[136:137], v[136:137], s[4:5]
    v_pk_mul_f32 v[138:139], v[138:139], s[4:5]
    v_cvt_pk_bf16_f32 v42, v136, v137
    v_cvt_pk_bf16_f32 v43, v138, v139
    ds_write_b64 v2, v[42:43] offset:5632
    v_pk_mul_f32 v[164:165], v[164:165], s[4:5]
    v_pk_mul_f32 v[166:167], v[166:167], s[4:5]
    v_cvt_pk_bf16_f32 v44, v164, v165
    v_cvt_pk_bf16_f32 v45, v166, v167
    ds_write_b64 v2, v[44:45] offset:9728
    v_pk_mul_f32 v[192:193], v[192:193], s[4:5]
    v_pk_mul_f32 v[194:195], v[194:195], s[4:5]
    v_cvt_pk_bf16_f32 v46, v192, v193
    v_cvt_pk_bf16_f32 v47, v194, v195
    ds_write_b64 v2, v[46:47] offset:13824
    s_waitcnt lgkmcnt(7)
    v_pk_mul_f32 v[112:113], v[112:113], s[4:5]
    v_pk_mul_f32 v[114:115], v[114:115], s[4:5]
    v_cvt_pk_bf16_f32 v16, v112, v113
    v_cvt_pk_bf16_f32 v17, v114, v115
    ds_write_b64 v2, v[16:17] offset:2048
    v_pk_mul_f32 v[140:141], v[140:141], s[4:5]
    v_pk_mul_f32 v[142:143], v[142:143], s[4:5]
    v_cvt_pk_bf16_f32 v18, v140, v141
    v_cvt_pk_bf16_f32 v19, v142, v143
    ds_write_b64 v2, v[18:19] offset:6144
    v_pk_mul_f32 v[168:169], v[168:169], s[4:5]
    v_pk_mul_f32 v[170:171], v[170:171], s[4:5]
    v_cvt_pk_bf16_f32 v20, v168, v169
    v_cvt_pk_bf16_f32 v21, v170, v171
    ds_write_b64 v2, v[20:21] offset:10240
    v_pk_mul_f32 v[196:197], v[196:197], s[4:5]
    v_pk_mul_f32 v[198:199], v[198:199], s[4:5]
    v_cvt_pk_bf16_f32 v22, v196, v197
    v_cvt_pk_bf16_f32 v23, v198, v199
    ds_write_b64 v2, v[22:23] offset:14336
    v_pk_mul_f32 v[116:117], v[116:117], s[4:5]
    v_pk_mul_f32 v[118:119], v[118:119], s[4:5]
    v_cvt_pk_bf16_f32 v24, v116, v117
    v_cvt_pk_bf16_f32 v25, v118, v119
    ds_write_b64 v2, v[24:25] offset:2560
    v_pk_mul_f32 v[144:145], v[144:145], s[4:5]
    v_pk_mul_f32 v[146:147], v[146:147], s[4:5]
    v_cvt_pk_bf16_f32 v26, v144, v145
    v_cvt_pk_bf16_f32 v27, v146, v147
    ds_write_b64 v2, v[26:27] offset:6656
    v_pk_mul_f32 v[172:173], v[172:173], s[4:5]
    v_pk_mul_f32 v[174:175], v[174:175], s[4:5]
    v_cvt_pk_bf16_f32 v28, v172, v173
    v_cvt_pk_bf16_f32 v29, v174, v175
    ds_write_b64 v2, v[28:29] offset:10752
    v_pk_mul_f32 v[200:201], v[200:201], s[4:5]
    v_pk_mul_f32 v[202:203], v[202:203], s[4:5]
    v_cvt_pk_bf16_f32 v30, v200, v201
    v_cvt_pk_bf16_f32 v31, v202, v203
    ds_write_b64 v2, v[30:31] offset:14848
    s_waitcnt lgkmcnt(7)
    v_pk_mul_f32 v[120:121], v[120:121], s[4:5]
    v_pk_mul_f32 v[122:123], v[122:123], s[4:5]
    v_cvt_pk_bf16_f32 v32, v120, v121
    v_cvt_pk_bf16_f32 v33, v122, v123
    ds_write_b64 v2, v[32:33] offset:3072
    v_pk_mul_f32 v[148:149], v[148:149], s[4:5]
    v_pk_mul_f32 v[150:151], v[150:151], s[4:5]
    v_cvt_pk_bf16_f32 v34, v148, v149
    v_cvt_pk_bf16_f32 v35, v150, v151
    ds_write_b64 v2, v[34:35] offset:7168
    v_pk_mul_f32 v[176:177], v[176:177], s[4:5]
    v_pk_mul_f32 v[178:179], v[178:179], s[4:5]
    v_cvt_pk_bf16_f32 v36, v176, v177
    v_cvt_pk_bf16_f32 v37, v178, v179
    ds_write_b64 v2, v[36:37] offset:11264
    v_pk_mul_f32 v[204:205], v[204:205], s[4:5]
    v_pk_mul_f32 v[206:207], v[206:207], s[4:5]
    v_cvt_pk_bf16_f32 v38, v204, v205
    v_cvt_pk_bf16_f32 v39, v206, v207
    ds_write_b64 v2, v[38:39] offset:15360
    s_waitcnt lgkmcnt(0)
    s_barrier
    ds_read_b128 v[16:19], v4 offset:0
    ds_read_b128 v[20:23], v4 offset:8192
    ds_read_b128 v[24:27], v4 offset:16384
    ds_read_b128 v[28:31], v4 offset:24576
    ds_read_b128 v[32:35], v4 offset:512
    ds_read_b128 v[36:39], v4 offset:8704
    ds_read_b128 v[40:43], v4 offset:16896
    ds_read_b128 v[44:47], v4 offset:25088
    ds_read_b128 v[48:51], v5 offset:0
    ds_read_b128 v[52:55], v5 offset:8192
    ds_read_b128 v[56:59], v5 offset:16384
    ds_read_b128 v[60:63], v5 offset:24576
    ds_read_b128 v[64:67], v5 offset:512
    ds_read_b128 v[68:71], v5 offset:8704
    ds_read_b128 v[72:75], v5 offset:16896
    ds_read_b128 v[76:79], v5 offset:25088
    s_waitcnt lgkmcnt(0)
    s_barrier
    s_cmp_eq_u32 s3, 3
    s_cbranch_scc1 HEAD1
HEAD2:
    ds_read_b128 v[208:211], v8 offset:0
    ds_read_b128 v[212:215], v9 offset:0
    ds_read_b128 v[216:219], v8 offset:1024
    ds_read_b128 v[220:223], v9 offset:1024
    ds_read_b128 v[224:227], v8 offset:4096
    ds_read_b128 v[228:231], v9 offset:4096
    ds_read_b128 v[232:235], v8 offset:5120
    ds_read_b128 v[236:239], v9 offset:5120
    s_waitcnt lgkmcnt(7)
    v_mfma_f32_16x16x32_bf16 v[160:163], v[208:211], v[16:19], 0
    v_mov_b32 v96, 0
    v_mov_b32 v97, 0
    v_mov_b32 v98, 0
    v_mov_b32 v99, 0
    v_mfma_f32_16x16x32_bf16 v[168:171], v[208:211], v[32:35], 0
    v_mov_b32 v100, 0
    v_mov_b32 v101, 0
    v_mov_b32 v102, 0
    v_mov_b32 v103, 0
    ds_read_b128 v[208:211], v8 offset:8192
    s_waitcnt lgkmcnt(7)
    v_mfma_f32_16x16x32_bf16 v[160:163], v[212:215], v[20:23], v[160:163]
    v_mov_b32 v104, 0
    v_mov_b32 v105, 0
    v_mov_b32 v106, 0
    v_mov_b32 v107, 0
    v_mfma_f32_16x16x32_bf16 v[168:171], v[212:215], v[36:39], v[168:171]
    v_mov_b32 v108, 0
    v_mov_b32 v109, 0
    v_mov_b32 v110, 0
    v_mov_b32 v111, 0
    ds_read_b128 v[212:215], v9 offset:8192
    s_waitcnt lgkmcnt(7)
    v_mfma_f32_16x16x32_bf16 v[160:163], v[216:219], v[24:27], v[160:163]
    v_mov_b32 v112, 0
    v_mov_b32 v113, 0
    v_mov_b32 v114, 0
    v_mov_b32 v115, 0
    v_mfma_f32_16x16x32_bf16 v[168:171], v[216:219], v[40:43], v[168:171]
    v_mov_b32 v116, 0
    v_mov_b32 v117, 0
    v_mov_b32 v118, 0
    v_mov_b32 v119, 0
    ds_read_b128 v[216:219], v8 offset:9216
    s_waitcnt lgkmcnt(7)
    v_mfma_f32_16x16x32_bf16 v[160:163], v[220:223], v[28:31], v[160:163]
    v_mov_b32 v120, 0
    v_mov_b32 v121, 0
    v_mov_b32 v122, 0
    v_mov_b32 v123, 0
    v_mfma_f32_16x16x32_bf16 v[168:171], v[220:223], v[44:47], v[168:171]
    v_mov_b32 v124, 0
    v_mov_b32 v125, 0
    v_mov_b32 v126, 0
    v_mov_b32 v127, 0
    ds_read_b128 v[220:223], v9 offset:9216
    s_waitcnt lgkmcnt(7)
    v_mfma_f32_16x16x32_bf16 v[164:167], v[224:227], v[16:19], 0
    v_mov_b32 v128, 0
    v_mov_b32 v129, 0
    v_mov_b32 v130, 0
    v_mov_b32 v131, 0
    v_mfma_f32_16x16x32_bf16 v[172:175], v[224:227], v[32:35], 0
    v_mov_b32 v132, 0
    v_mov_b32 v133, 0
    v_mov_b32 v134, 0
    v_mov_b32 v135, 0
    ds_read_b128 v[224:227], v8 offset:12288
    s_waitcnt lgkmcnt(7)
    v_mfma_f32_16x16x32_bf16 v[164:167], v[228:231], v[20:23], v[164:167]
    v_mov_b32 v136, 0
    v_mov_b32 v137, 0
    v_mov_b32 v138, 0
    v_mov_b32 v139, 0
    v_mfma_f32_16x16x32_bf16 v[172:175], v[228:231], v[36:39], v[172:175]
    v_mov_b32 v140, 0
    v_mov_b32 v141, 0
    v_mov_b32 v142, 0
    v_mov_b32 v143, 0
    ds_read_b128 v[228:231], v9 offset:12288
    s_waitcnt lgkmcnt(7)
    v_mfma_f32_16x16x32_bf16 v[164:167], v[232:235], v[24:27], v[164:167]
    v_mov_b32 v144, 0
    v_mov_b32 v145, 0
    v_mov_b32 v146, 0
    v_mov_b32 v147, 0
    v_mfma_f32_16x16x32_bf16 v[172:175], v[232:235], v[40:43], v[172:175]
    v_mov_b32 v148, 0
    v_mov_b32 v149, 0
    v_mov_b32 v150, 0
    v_mov_b32 v151, 0
    ds_read_b128 v[232:235], v8 offset:13312
    s_waitcnt lgkmcnt(7)
    v_mfma_f32_16x16x32_bf16 v[164:167], v[236:239], v[28:31], v[164:167]
    v_mov_b32 v152, 0
    v_mov_b32 v153, 0
    v_mov_b32 v154, 0
    v_mov_b32 v155, 0
    v_mfma_f32_16x16x32_bf16 v[172:175], v[236:239], v[44:47], v[172:175]
    v_mov_b32 v156, 0
    v_mov_b32 v157, 0
    v_mov_b32 v158, 0
    v_mov_b32 v159, 0
    ds_read_b128 v[236:239], v9 offset:13312
    v_mov_b32 v244, 0
    v_mov_b32 v245, 0
    s_nop 3
    v_max3_f32 v248, v160, v161, v162
    v_max3_f32 v249, v168, v169, v170
    v_max3_f32 v248, v248, v163, v164
    v_max3_f32 v249, v249, v171, v172
    v_max3_f32 v248, v248, v165, v166
    v_max3_f32 v249, v249, v173, v174
    v_max_f32 v248, v248, v167
    v_max_f32 v249, v249, v175
    v_mov_b32 v250, v248
    v_mov_b32 v251, v249
    s_nop 0
    v_permlane16_swap_b32 v248, v250
    v_permlane16_swap_b32 v249, v251
    v_max_f32 v248, v248, v250
    v_max_f32 v249, v249, v251
    v_mov_b32 v250, v248
    v_mov_b32 v251, v249
    s_nop 0
    v_permlane32_swap_b32 v248, v250
    v_permlane32_swap_b32 v249, v251
    v_max_f32 v248, v248, v250
    v_max_f32 v249, v249, v251
    v_sub_f32 v192, 0, v248
    v_sub_f32 v193, 0, v248
    v_sub_f32 v194, 0, v248
    v_sub_f32 v195, 0, v248
    v_sub_f32 v196, 0, v249
    v_sub_f32 v197, 0, v249
    v_sub_f32 v198, 0, v249
    v_sub_f32 v199, 0, v249
    v_pk_add_f32 v[160:161], v[160:161], v[192:193]
    v_pk_add_f32 v[162:163], v[162:163], v[192:193]
    v_pk_add_f32 v[164:165], v[164:165], v[192:193]
    v_pk_add_f32 v[166:167], v[166:167], v[192:193]
    v_pk_add_f32 v[168:169], v[168:169], v[196:197]
    v_pk_add_f32 v[170:171], v[170:171], v[196:197]
    v_pk_add_f32 v[172:173], v[172:173], v[196:197]
    v_pk_add_f32 v[174:175], v[174:175], v[196:197]
    s_waitcnt lgkmcnt(7)
    v_mfma_f32_16x16x32_bf16 v[176:179], v[208:211], v[16:19], v[192:195]
    v_exp_f32 v240, v160
    v_exp_f32 v241, v161
    v_mfma_f32_16x16x32_bf16 v[184:187], v[208:211], v[32:35], v[196:199]
    v_exp_f32 v242, v162
    v_exp_f32 v243, v163
    s_waitcnt lgkmcnt(6)
    v_mfma_f32_16x16x32_bf16 v[176:179], v[212:215], v[20:23], v[176:179]
    v_add_f32 v246, v240, v241
    v_cvt_pk_bf16_f32 v80, v240, v241
    v_exp_f32 v240, v164
    v_mfma_f32_16x16x32_bf16 v[184:187], v[212:215], v[36:39], v[184:187]
    v_exp_f32 v241, v165
    v_add_f32 v246, v246, v242
    s_waitcnt lgkmcnt(5)
    v_mfma_f32_16x16x32_bf16 v[176:179], v[216:219], v[24:27], v[176:179]
    v_cvt_pk_bf16_f32 v81, v242, v243
    v_add_f32 v246, v246, v243
    v_mfma_f32_16x16x32_bf16 v[184:187], v[216:219], v[40:43], v[184:187]
    v_exp_f32 v242, v166
    v_exp_f32 v243, v167
    v_add_f32 v246, v246, v240
    s_waitcnt lgkmcnt(4)
    v_mfma_f32_16x16x32_bf16 v[176:179], v[220:223], v[28:31], v[176:179]
    v_cvt_pk_bf16_f32 v82, v240, v241
    v_add_f32 v246, v246, v241
    v_mfma_f32_16x16x32_bf16 v[184:187], v[220:223], v[44:47], v[184:187]
    v_exp_f32 v240, v168
    v_exp_f32 v241, v169
    v_add_f32 v246, v246, v242
    s_waitcnt lgkmcnt(3)
    v_mfma_f32_16x16x32_bf16 v[180:183], v[224:227], v[16:19], v[192:195]
    v_cvt_pk_bf16_f32 v83, v242, v243
    v_add_f32 v246, v246, v243
    v_mfma_f32_16x16x32_bf16 v[188:191], v[224:227], v[32:35], v[196:199]
    v_exp_f32 v242, v170
    v_exp_f32 v243, v171
    s_waitcnt lgkmcnt(2)
    v_mfma_f32_16x16x32_bf16 v[180:183], v[228:231], v[20:23], v[180:183]
    v_add_f32 v247, v240, v241
    v_cvt_pk_bf16_f32 v84, v240, v241
    v_exp_f32 v240, v172
    v_mfma_f32_16x16x32_bf16 v[188:191], v[228:231], v[36:39], v[188:191]
    v_exp_f32 v241, v173
    v_add_f32 v247, v247, v242
    s_waitcnt lgkmcnt(1)
    v_mfma_f32_16x16x32_bf16 v[180:183], v[232:235], v[24:27], v[180:183]
    v_cvt_pk_bf16_f32 v85, v242, v243
    v_add_f32 v247, v247, v243
    v_mfma_f32_16x16x32_bf16 v[188:191], v[232:235], v[40:43], v[188:191]
    v_exp_f32 v242, v174
    v_exp_f32 v243, v175
    v_add_f32 v247, v247, v240
    s_waitcnt lgkmcnt(0)
    v_mfma_f32_16x16x32_bf16 v[180:183], v[236:239], v[28:31], v[180:183]
    v_cvt_pk_bf16_f32 v86, v240, v241
    v_add_f32 v247, v247, v241
    v_mfma_f32_16x16x32_bf16 v[188:191], v[236:239], v[44:47], v[188:191]
    v_add_f32 v247, v247, v242
    v_cvt_pk_bf16_f32 v87, v242, v243
    v_add_f32 v247, v247, v243
    v_add_f32 v244, v244, v246
    v_add_f32 v245, v245, v247
    s_add_u32 s79, s74, 32768
    s_cmp_ge_u32 s79, s47
    s_cselect_b32 s79, 0, s79
    s_sub_u32 s92, s79, s74
    s_mov_b32 s74, s79
    v_add_u32 v8, s92, v8
    v_add_u32 v9, s92, v9
    s_add_u32 s79, s75, 32768
    s_cmp_ge_u32 s79, s47
    s_cselect_b32 s79, 0, s79
    s_sub_u32 s92, s79, s75
    s_mov_b32 s75, s79
    v_add_u32 v10, s92, v10
    v_add_u32 v11, s92, v11
    v_add_u32 v12, s92, v12
    v_add_u32 v13, s92, v13
    s_waitcnt lgkmcnt(0)
    s_barrier
    ds_read_b128 v[208:211], v8 offset:0
    ds_read_b128 v[212:215], v9 offset:0
    ds_read_b128 v[216:219], v8 offset:1024
    ds_read_b128 v[220:223], v9 offset:1024
    ds_read_b128 v[224:227], v8 offset:4096
    ds_read_b128 v[228:231], v9 offset:4096
    ds_read_b128 v[232:235], v8 offset:5120
    ds_read_b128 v[236:239], v9 offset:5120
    s_mov_b32 s72, 15
ATT_LOOP2:
    s_waitcnt lgkmcnt(4)
    v_mfma_f32_16x16x32_bf16 v[160:163], v[208:211], v[16:19], v[192:195]
    v_exp_f32 v240, v176
    v_mfma_f32_16x16x32_bf16 v[168:171], v[208:211], v[32:35], v[196:199]
    ds_read_b64_tr_b16 v[208:209], v10 offset:0
    v_exp_f32 v241, v177
    v_mfma_f32_16x16x32_bf16 v[160:163], v[212:215], v[20:23], v[160:163]
    ds_read_b64_tr_b16 v[210:211], v10 offset:4096
    v_exp_f32 v242, v178
    v_mfma_f32_16x16x32_bf16 v[168:171], v[212:215], v[36:39], v[168:171]
    ds_read_b64_tr_b16 v[212:213], v11 offset:0
    v_exp_f32 v243, v179
    v_mfma_f32_16x16x32_bf16 v[160:163], v[216:219], v[24:27], v[160:163]
    ds_read_b64_tr_b16 v[214:215], v11 offset:4096
    v_add_f32 v246, v240, v241
    v_cvt_pk_bf16_f32 v88, v240, v241
    v_mfma_f32_16x16x32_bf16 v[168:171], v[216:219], v[40:43], v[168:171]
    ds_read_b64_tr_b16 v[216:217], v12 offset:0
    v_exp_f32 v240, v180
    v_mfma_f32_16x16x32_bf16 v[160:163], v[220:223], v[28:31], v[160:163]
    ds_read_b64_tr_b16 v[218:219], v12 offset:4096
    v_exp_f32 v241, v181
    v_mfma_f32_16x16x32_bf16 v[168:171], v[220:223], v[44:47], v[168:171]
    ds_read_b64_tr_b16 v[220:221], v13 offset:0
    s_waitcnt lgkmcnt(7)
    v_mfma_f32_16x16x32_bf16 v[164:167], v[224:227], v[16:19], v[192:195]
    ds_read_b64_tr_b16 v[222:223], v13 offset:4096
    v_add_f32 v246, v246, v242
    v_cvt_pk_bf16_f32 v89, v242, v243
    v_mfma_f32_16x16x32_bf16 v[172:175], v[224:227], v[32:35], v[196:199]
    ds_read_b64_tr_b16 v[224:225], v10 offset:1024
    v_add_f32 v246, v246, v243
    v_mfma_f32_16x16x32_bf16 v[164:167], v[228:231], v[20:23], v[164:167]
    ds_read_b64_tr_b16 v[226:227], v10 offset:5120
    v_exp_f32 v242, v182
    v_mfma_f32_16x16x32_bf16 v[172:175], v[228:231], v[36:39], v[172:175]
    ds_read_b64_tr_b16 v[228:229], v11 offset:1024
    v_exp_f32 v243, v183
    v_mfma_f32_16x16x32_bf16 v[164:167], v[232:235], v[24:27], v[164:167]
    ds_read_b64_tr_b16 v[230:231], v11 offset:5120
    v_add_f32 v246, v246, v240
    v_cvt_pk_bf16_f32 v90, v240, v241
    v_mfma_f32_16x16x32_bf16 v[172:175], v[232:235], v[40:43], v[172:175]
    ds_read_b64_tr_b16 v[232:233], v12 offset:1024
    v_add_f32 v246, v246, v241
    v_mfma_f32_16x16x32_bf16 v[164:167], v[236:239], v[28:31], v[164:167]
    ds_read_b64_tr_b16 v[234:235], v12 offset:5120
    v_exp_f32 v240, v184
    v_mfma_f32_16x16x32_bf16 v[172:175], v[236:239], v[44:47], v[172:175]
    ds_read_b64_tr_b16 v[236:237], v13 offset:1024
    v_exp_f32 v241, v185
    s_waitcnt lgkmcnt(7)
    v_mfma_f32_16x16x32_bf16 v[96:99], v[208:211], v[80:83], v[96:99]
    ds_read_b64_tr_b16 v[238:239], v13 offset:5120
    v_add_f32 v246, v246, v242
    v_mfma_f32_16x16x32_bf16 v[100:103], v[208:211], v[84:87], v[100:103]
    v_cvt_pk_bf16_f32 v91, v242, v243
    v_add_f32 v246, v246, v243
    v_mfma_f32_16x16x32_bf16 v[104:107], v[212:215], v[80:83], v[104:107]
    v_exp_f32 v242, v186
    v_exp_f32 v243, v187
    v_mfma_f32_16x16x32_bf16 v[108:111], v[212:215], v[84:87], v[108:111]
    v_add_f32 v247, v240, v241
    v_cvt_pk_bf16_f32 v92, v240, v241
    v_mfma_f32_16x16x32_bf16 v[112:115], v[216:219], v[80:83], v[112:115]
    v_exp_f32 v240, v188
    v_mfma_f32_16x16x32_bf16 v[116:119], v[216:219], v[84:87], v[116:119]
    v_exp_f32 v241, v189
    v_add_f32 v247, v247, v242
    v_cvt_pk_bf16_f32 v93, v242, v243
    v_mfma_f32_16x16x32_bf16 v[120:123], v[220:223], v[80:83], v[120:123]
    v_add_f32 v247, v247, v243
    v_exp_f32 v242, v190
    v_mfma_f32_16x16x32_bf16 v[124:127], v[220:223], v[84:87], v[124:127]
    s_waitcnt vmcnt(0) lgkmcnt(0)
    s_barrier
    v_mfma_f32_16x16x32_bf16 v[128:131], v[224:227], v[80:83], v[128:131]
    ds_read_b128 v[208:211], v8 offset:8192
    v_exp_f32 v243, v191
    v_mfma_f32_16x16x32_bf16 v[132:135], v[224:227], v[84:87], v[132:135]
    ds_read_b128 v[212:215], v9 offset:8192
    v_add_f32 v247, v247, v240
    v_cvt_pk_bf16_f32 v94, v240, v241
    v_mfma_f32_16x16x32_bf16 v[136:139], v[228:231], v[80:83], v[136:139]
    ds_read_b128 v[216:219], v8 offset:9216
    v_add_f32 v247, v247, v241
    v_mfma_f32_16x16x32_bf16 v[140:143], v[228:231], v[84:87], v[140:143]
    ds_read_b128 v[220:223], v9 offset:9216
    v_add_f32 v247, v247, v242
    v_cvt_pk_bf16_f32 v95, v242, v243
    v_mfma_f32_16x16x32_bf16 v[144:147], v[232:235], v[80:83], v[144:147]
    ds_read_b128 v[224:227], v8 offset:12288
    v_add_f32 v247, v247, v243
    v_max_f32 v248, v246, v247
    v_mfma_f32_16x16x32_bf16 v[148:151], v[232:235], v[84:87], v[148:151]
    ds_read_b128 v[228:231], v9 offset:12288
    v_cmp_lt_f32 vcc, s78, v248
    v_mfma_f32_16x16x32_bf16 v[152:155], v[236:239], v[80:83], v[152:155]
    ds_read_b128 v[232:235], v8 offset:13312
    v_mfma_f32_16x16x32_bf16 v[156:159], v[236:239], v[84:87], v[156:159]
    ds_read_b128 v[236:239], v9 offset:13312
    s_cbranch_vccnz SLOW1_B2
RET1_B2:
    v_add_f32 v244, v244, v246
    v_add_f32 v245, v245, v247
    s_waitcnt lgkmcnt(4)
    v_mfma_f32_16x16x32_bf16 v[176:179], v[208:211], v[16:19], v[192:195]
    s_add_u32 s79, s74, 32768
    v_exp_f32 v240, v160
    v_mfma_f32_16x16x32_bf16 v[184:187], v[208:211], v[32:35], v[196:199]
    ds_read_b64_tr_b16 v[208:209], v10 offset:8192
    s_cmp_ge_u32 s79, s47
    v_exp_f32 v241, v161
    v_mfma_f32_16x16x32_bf16 v[176:179], v[212:215], v[20:23], v[176:179]
    ds_read_b64_tr_b16 v[210:211], v10 offset:12288
    s_cselect_b32 s79, 0, s79
    v_mfma_f32_16x16x32_bf16 v[184:187], v[212:215], v[36:39], v[184:187]
    ds_read_b64_tr_b16 v[212:213], v11 offset:8192
    s_sub_u32 s92, s79, s74
    v_exp_f32 v242, v162
    v_mfma_f32_16x16x32_bf16 v[176:179], v[216:219], v[24:27], v[176:179]
    ds_read_b64_tr_b16 v[214:215], v11 offset:12288
    s_mov_b32 s74, s79
    v_exp_f32 v243, v163
    v_mfma_f32_16x16x32_bf16 v[184:187], v[216:219], v[40:43], v[184:187]
    ds_read_b64_tr_b16 v[216:217], v12 offset:8192
    v_add_u32 v8, s92, v8
    v_add_f32 v246, v240, v241
    v_mfma_f32_16x16x32_bf16 v[176:179], v[220:223], v[28:31], v[176:179]
    ds_read_b64_tr_b16 v[218:219], v12 offset:12288
    v_add_u32 v9, s92, v9
    v_cvt_pk_bf16_f32 v80, v240, v241
    v_mfma_f32_16x16x32_bf16 v[184:187], v[220:223], v[44:47], v[184:187]
    ds_read_b64_tr_b16 v[220:221], v13 offset:8192
    v_exp_f32 v240, v164
    s_waitcnt lgkmcnt(7)
    v_mfma_f32_16x16x32_bf16 v[180:183], v[224:227], v[16:19], v[192:195]
    ds_read_b64_tr_b16 v[222:223], v13 offset:12288
    v_exp_f32 v241, v165
    v_mfma_f32_16x16x32_bf16 v[188:191], v[224:227], v[32:35], v[196:199]
    ds_read_b64_tr_b16 v[224:225], v10 offset:9216
    v_add_f32 v246, v246, v242
    v_cvt_pk_bf16_f32 v81, v242, v243
    v_mfma_f32_16x16x32_bf16 v[180:183], v[228:231], v[20:23], v[180:183]
    ds_read_b64_tr_b16 v[226:227], v10 offset:13312
    v_add_f32 v246, v246, v243
    v_exp_f32 v242, v166
    v_mfma_f32_16x16x32_bf16 v[188:191], v[228:231], v[36:39], v[188:191]
    ds_read_b64_tr_b16 v[228:229], v11 offset:9216
    v_exp_f32 v243, v167
    v_mfma_f32_16x16x32_bf16 v[180:183], v[232:235], v[24:27], v[180:183]
    ds_read_b64_tr_b16 v[230:231], v11 offset:13312
    v_add_f32 v246, v246, v240
    v_cvt_pk_bf16_f32 v82, v240, v241
    v_mfma_f32_16x16x32_bf16 v[188:191], v[232:235], v[40:43], v[188:191]
    ds_read_b64_tr_b16 v[232:233], v12 offset:9216
    v_add_f32 v246, v246, v241
    v_exp_f32 v240, v168
    v_mfma_f32_16x16x32_bf16 v[180:183], v[236:239], v[28:31], v[180:183]
    ds_read_b64_tr_b16 v[234:235], v12 offset:13312
    v_exp_f32 v241, v169
    v_mfma_f32_16x16x32_bf16 v[188:191], v[236:239], v[44:47], v[188:191]
    ds_read_b64_tr_b16 v[236:237], v13 offset:9216
    v_add_f32 v246, v246, v242
    s_waitcnt lgkmcnt(7)
    v_mfma_f32_16x16x32_bf16 v[96:99], v[208:211], v[88:91], v[96:99]
    ds_read_b64_tr_b16 v[238:239], v13 offset:13312
    v_cvt_pk_bf16_f32 v83, v242, v243
    v_add_f32 v246, v246, v243
    v_mfma_f32_16x16x32_bf16 v[100:103], v[208:211], v[92:95], v[100:103]
    s_add_u32 s79, s75, 32768
    v_exp_f32 v242, v170
    v_mfma_f32_16x16x32_bf16 v[104:107], v[212:215], v[88:91], v[104:107]
    s_cmp_ge_u32 s79, s47
    v_exp_f32 v243, v171
    v_add_f32 v247, v240, v241
    v_mfma_f32_16x16x32_bf16 v[108:111], v[212:215], v[92:95], v[108:111]
    s_cselect_b32 s79, 0, s79
    v_cvt_pk_bf16_f32 v84, v240, v241
    v_exp_f32 v240, v172
    v_mfma_f32_16x16x32_bf16 v[112:115], v[216:219], v[88:91], v[112:115]
    s_sub_u32 s92, s79, s75
    v_exp_f32 v241, v173
    v_mfma_f32_16x16x32_bf16 v[116:119], v[216:219], v[92:95], v[116:119]
    s_mov_b32 s75, s79
    v_add_f32 v247, v247, v242
    v_cvt_pk_bf16_f32 v85, v242, v243
    v_mfma_f32_16x16x32_bf16 v[120:123], v[220:223], v[88:91], v[120:123]
    v_add_u32 v10, s92, v10
    v_add_f32 v247, v247, v243
    v_exp_f32 v242, v174
    v_mfma_f32_16x16x32_bf16 v[124:127], v[220:223], v[92:95], v[124:127]
    v_add_u32 v11, s92, v11
    s_waitcnt vmcnt(0) lgkmcnt(0)
    s_barrier
    v_mfma_f32_16x16x32_bf16 v[128:131], v[224:227], v[88:91], v[128:131]
    ds_read_b128 v[208:211], v8 offset:0
    v_add_u32 v12, s92, v12
    v_mfma_f32_16x16x32_bf16 v[132:135], v[224:227], v[92:95], v[132:135]
    ds_read_b128 v[212:215], v9 offset:0
    v_add_u32 v13, s92, v13
    v_exp_f32 v243, v175
    v_mfma_f32_16x16x32_bf16 v[136:139], v[228:231], v[88:91], v[136:139]
    ds_read_b128 v[216:219], v8 offset:1024
    v_add_f32 v247, v247, v240
    v_cvt_pk_bf16_f32 v86, v240, v241
    v_mfma_f32_16x16x32_bf16 v[140:143], v[228:231], v[92:95], v[140:143]
    ds_read_b128 v[220:223], v9 offset:1024
    v_add_f32 v247, v247, v241
    v_add_f32 v247, v247, v242
    v_cvt_pk_bf16_f32 v87, v242, v243
    v_mfma_f32_16x16x32_bf16 v[144:147], v[232:235], v[88:91], v[144:147]
    ds_read_b128 v[224:227], v8 offset:4096
    v_add_f32 v247, v247, v243
    v_max_f32 v248, v246, v247
    v_mfma_f32_16x16x32_bf16 v[148:151], v[232:235], v[92:95], v[148:151]
    ds_read_b128 v[228:231], v9 offset:4096
    v_cmp_lt_f32 vcc, s78, v248
    v_mfma_f32_16x16x32_bf16 v[152:155], v[236:239], v[88:91], v[152:155]
    ds_read_b128 v[232:235], v8 offset:5120
    s_sub_u32 s72, s72, 1
    s_cmp_lg_u32 s72, 0
    v_mfma_f32_16x16x32_bf16 v[156:159], v[236:239], v[92:95], v[156:159]
    ds_read_b128 v[236:239], v9 offset:5120
    s_cbranch_vccnz SLOW0_B2
RET0_B2:
    v_add_f32 v244, v244, v246
    v_add_f32 v245, v245, v247
    s_cbranch_scc1 ATT_LOOP2
    s_lshl_b32 s77, s73, 16
    ds_read_b64_tr_b16 v[208:209], v10 offset:0
    ds_read_b64_tr_b16 v[210:211], v10 offset:4096
    ds_read_b64_tr_b16 v[212:213], v11 offset:0
    ds_read_b64_tr_b16 v[214:215], v11 offset:4096
    ds_read_b64_tr_b16 v[216:217], v12 offset:0
    ds_read_b64_tr_b16 v[218:219], v12 offset:4096
    s_waitcnt lgkmcnt(4)
    v_mfma_f32_16x16x32_bf16 v[96:99], v[208:211], v[80:83], v[96:99]
    v_exp_f32 v240, v176
    v_exp_f32 v241, v177
    v_mfma_f32_16x16x32_bf16 v[100:103], v[208:211], v[84:87], v[100:103]
    v_exp_f32 v242, v178
    v_exp_f32 v243, v179
    v_add_f32 v246, v240, v241
    ds_read_b64_tr_b16 v[220:221], v13 offset:0
    ds_read_b64_tr_b16 v[222:223], v13 offset:4096
    ds_read_b64_tr_b16 v[224:225], v10 offset:1024
    ds_read_b64_tr_b16 v[226:227], v10 offset:5120
    ds_read_b64_tr_b16 v[228:229], v11 offset:1024
    ds_read_b64_tr_b16 v[230:231], v11 offset:5120
    ds_read_b64_tr_b16 v[232:233], v12 offset:1024
    ds_read_b64_tr_b16 v[234:235], v12 offset:5120
    ds_read_b64_tr_b16 v[236:237], v13 offset:1024
    ds_read_b64_tr_b16 v[238:239], v13 offset:5120
    s_waitcnt lgkmcnt(12)
    v_mfma_f32_16x16x32_bf16 v[104:107], v[212:215], v[80:83], v[104:107]
    v_cvt_pk_bf16_f32 v88, v240, v241
    v_exp_f32 v240, v180
    v_mfma_f32_16x16x32_bf16 v[108:111], v[212:215], v[84:87], v[108:111]
    v_exp_f32 v241, v181
    v_add_f32 v246, v246, v242
    v_cvt_pk_bf16_f32 v89, v242, v243
    s_waitcnt lgkmcnt(10)
    v_mfma_f32_16x16x32_bf16 v[112:115], v[216:219], v[80:83], v[112:115]
    v_add_f32 v246, v246, v243
    v_exp_f32 v242, v182
    v_mfma_f32_16x16x32_bf16 v[116:119], v[216:219], v[84:87], v[116:119]
    v_exp_f32 v243, v183
    v_add_f32 v246, v246, v240
    v_cvt_pk_bf16_f32 v90, v240, v241
    s_waitcnt lgkmcnt(8)
    v_mfma_f32_16x16x32_bf16 v[120:123], v[220:223], v[80:83], v[120:123]
    v_add_f32 v246, v246, v241
    v_exp_f32 v240, v184
    v_mfma_f32_16x16x32_bf16 v[124:127], v[220:223], v[84:87], v[124:127]
    v_exp_f32 v241, v185
    v_add_f32 v246, v246, v242
    v_cvt_pk_bf16_f32 v91, v242, v243
    s_waitcnt lgkmcnt(0)
    s_barrier
    v_mfma_f32_16x16x32_bf16 v[128:131], v[224:227], v[80:83], v[128:131]
    v_add_f32 v246, v246, v243
    v_exp_f32 v242, v186
    v_mfma_f32_16x16x32_bf16 v[132:135], v[224:227], v[84:87], v[132:135]
    v_exp_f32 v243, v187
    v_add_f32 v247, v240, v241
    v_cvt_pk_bf16_f32 v92, v240, v241
    ds_read_b64_tr_b16 v[208:209], v10 offset:8192
    ds_read_b64_tr_b16 v[210:211], v10 offset:12288
    ds_read_b64_tr_b16 v[212:213], v11 offset:8192
    ds_read_b64_tr_b16 v[214:215], v11 offset:12288
    ds_read_b64_tr_b16 v[216:217], v12 offset:8192
    ds_read_b64_tr_b16 v[218:219], v12 offset:12288
    ds_read_b64_tr_b16 v[220:221], v13 offset:8192
    ds_read_b64_tr_b16 v[222:223], v13 offset:12288
    ds_read_b64_tr_b16 v[224:225], v10 offset:9216
    ds_read_b64_tr_b16 v[226:227], v10 offset:13312
    v_mfma_f32_16x16x32_bf16 v[136:139], v[228:231], v[80:83], v[136:139]
    v_exp_f32 v240, v188
    v_exp_f32 v241, v189
    v_mfma_f32_16x16x32_bf16 v[140:143], v[228:231], v[84:87], v[140:143]
    v_add_f32 v247, v247, v242
    v_cvt_pk_bf16_f32 v93, v242, v243
    v_add_f32 v247, v247, v243
    ds_read_b64_tr_b16 v[228:229], v11 offset:9216
    ds_read_b64_tr_b16 v[230:231], v11 offset:13312
    v_mfma_f32_16x16x32_bf16 v[144:147], v[232:235], v[80:83], v[144:147]
    v_exp_f32 v242, v190
    v_exp_f32 v243, v191
    v_mfma_f32_16x16x32_bf16 v[148:151], v[232:235], v[84:87], v[148:151]
    v_add_f32 v247, v247, v240
    v_cvt_pk_bf16_f32 v94, v240, v241
    v_add_f32 v247, v247, v241
    ds_read_b64_tr_b16 v[232:233], v12 offset:9216
    ds_read_b64_tr_b16 v[234:235], v12 offset:13312
    v_mfma_f32_16x16x32_bf16 v[152:155], v[236:239], v[80:83], v[152:155]
    v_add_f32 v247, v247, v242
    v_cvt_pk_bf16_f32 v95, v242, v243
    v_mfma_f32_16x16x32_bf16 v[156:159], v[236:239], v[84:87], v[156:159]
    v_add_f32 v247, v247, v243
    v_max_f32 v248, v246, v247
    v_cmp_lt_f32 vcc, s78, v248
    s_cbranch_vccnz SLOW1_E2
RET1_E2:
    v_add_f32 v244, v244, v246
    v_add_f32 v245, v245, v247
    s_nop 0
    s_waitcnt lgkmcnt(12)
    v_mfma_f32_16x16x32_bf16 v[96:99], v[208:211], v[88:91], v[96:99]
    v_mov_b32 v240, v244
    v_mov_b32 v241, v245
    s_nop 0
    v_mfma_f32_16x16x32_bf16 v[100:103], v[208:211], v[92:95], v[100:103]
    v_permlane16_swap_b32 v244, v240
    v_permlane16_swap_b32 v245, v241
    v_add_f32 v244, v244, v240
    ds_read_b64_tr_b16 v[236:237], v13 offset:9216
    ds_read_b64_tr_b16 v[238:239], v13 offset:13312
    s_waitcnt lgkmcnt(12)
    v_mfma_f32_16x16x32_bf16 v[104:107], v[212:215], v[88:91], v[104:107]
    v_add_f32 v245, v245, v241
    v_mov_b32 v240, v244
    v_mov_b32 v241, v245
    v_mfma_f32_16x16x32_bf16 v[108:111], v[212:215], v[92:95], v[108:111]
    s_nop 0
    v_permlane32_swap_b32 v244, v240
    v_permlane32_swap_b32 v245, v241
    s_waitcnt lgkmcnt(10)
    v_mfma_f32_16x16x32_bf16 v[112:115], v[216:219], v[88:91], v[112:115]
    v_add_f32 v244, v244, v240
    v_add_f32 v245, v245, v241
    v_rcp_f32 v248, v244
    v_mfma_f32_16x16x32_bf16 v[116:119], v[216:219], v[92:95], v[116:119]
    v_rcp_f32 v250, v245
    s_nop 0
    s_waitcnt lgkmcnt(8)
    v_mfma_f32_16x16x32_bf16 v[120:123], v[220:223], v[88:91], v[120:123]
    v_mfma_f32_16x16x32_bf16 v[124:127], v[220:223], v[92:95], v[124:127]
    s_waitcnt lgkmcnt(6)
    v_mfma_f32_16x16x32_bf16 v[128:131], v[224:227], v[88:91], v[128:131]
    v_mfma_f32_16x16x32_bf16 v[132:135], v[224:227], v[92:95], v[132:135]
    s_waitcnt lgkmcnt(4)
    v_mfma_f32_16x16x32_bf16 v[136:139], v[228:231], v[88:91], v[136:139]
    v_mfma_f32_16x16x32_bf16 v[140:143], v[228:231], v[92:95], v[140:143]
    s_waitcnt lgkmcnt(2)
    v_mfma_f32_16x16x32_bf16 v[144:147], v[232:235], v[88:91], v[144:147]
    v_mfma_f32_16x16x32_bf16 v[148:151], v[232:235], v[92:95], v[148:151]
    s_waitcnt lgkmcnt(0)
    v_mfma_f32_16x16x32_bf16 v[152:155], v[236:239], v[88:91], v[152:155]
    v_mfma_f32_16x16x32_bf16 v[156:159], v[236:239], v[92:95], v[156:159]
    v_pk_mul_f32 v[96:97], v[96:97], v[248:249] op_sel_hi:[1,0]
    v_pk_mul_f32 v[98:99], v[98:99], v[248:249] op_sel_hi:[1,0]
    v_cvt_pk_bf16_f32 v208, v96, v97
    v_cvt_pk_bf16_f32 v209, v98, v99
    v_pk_mul_f32 v[104:105], v[104:105], v[248:249] op_sel_hi:[1,0]
    v_pk_mul_f32 v[106:107], v[106:107], v[248:249] op_sel_hi:[1,0]
    v_cvt_pk_bf16_f32 v210, v104, v105
    v_cvt_pk_bf16_f32 v211, v106, v107
    v_pk_mul_f32 v[100:101], v[100:101], v[250:251] op_sel_hi:[1,0]
    v_pk_mul_f32 v[102:103], v[102:103], v[250:251] op_sel_hi:[1,0]
    v_cvt_pk_bf16_f32 v224, v100, v101
    v_cvt_pk_bf16_f32 v225, v102, v103
    v_pk_mul_f32 v[108:109], v[108:109], v[250:251] op_sel_hi:[1,0]
    v_pk_mul_f32 v[110:111], v[110:111], v[250:251] op_sel_hi:[1,0]
    v_cvt_pk_bf16_f32 v226, v108, v109
    v_cvt_pk_bf16_f32 v227, v110, v111
    v_pk_mul_f32 v[112:113], v[112:113], v[248:249] op_sel_hi:[1,0]
    v_pk_mul_f32 v[114:115], v[114:115], v[248:249] op_sel_hi:[1,0]
    v_cvt_pk_bf16_f32 v212, v112, v113
    v_cvt_pk_bf16_f32 v213, v114, v115
    v_pk_mul_f32 v[120:121], v[120:121], v[248:249] op_sel_hi:[1,0]
    v_pk_mul_f32 v[122:123], v[122:123], v[248:249] op_sel_hi:[1,0]
    v_cvt_pk_bf16_f32 v214, v120, v121
    v_cvt_pk_bf16_f32 v215, v122, v123
    v_pk_mul_f32 v[116:117], v[116:117], v[250:251] op_sel_hi:[1,0]
    v_pk_mul_f32 v[118:119], v[118:119], v[250:251] op_sel_hi:[1,0]
    v_cvt_pk_bf16_f32 v228, v116, v117
    v_cvt_pk_bf16_f32 v229, v118, v119
    v_pk_mul_f32 v[124:125], v[124:125], v[250:251] op_sel_hi:[1,0]
    v_pk_mul_f32 v[126:127], v[126:127], v[250:251] op_sel_hi:[1,0]
    v_cvt_pk_bf16_f32 v230, v124, v125
    v_cvt_pk_bf16_f32 v231, v126, v127
    v_permlane16_swap_b32 v208, v210
    v_permlane16_swap_b32 v209, v211
    buffer_store_dwordx4 v[208:211], v14, s[64:67], s77 offen offset:0 sc0 sc1
    v_permlane16_swap_b32 v224, v226
    v_permlane16_swap_b32 v225, v227
    buffer_store_dwordx4 v[224:227], v14, s[64:67], s77 offen offset:512 sc0 sc1
    s_add_u32 s77, s77, 14336
    v_pk_mul_f32 v[128:129], v[128:129], v[248:249] op_sel_hi:[1,0]
    v_pk_mul_f32 v[130:131], v[130:131], v[248:249] op_sel_hi:[1,0]
    v_cvt_pk_bf16_f32 v216, v128, v129
    v_cvt_pk_bf16_f32 v217, v130, v131
    v_pk_mul_f32 v[136:137], v[136:137], v[248:249] op_sel_hi:[1,0]
    v_pk_mul_f32 v[138:139], v[138:139], v[248:249] op_sel_hi:[1,0]
    v_cvt_pk_bf16_f32 v218, v136, v137
    v_cvt_pk_bf16_f32 v219, v138, v139
    v_pk_mul_f32 v[132:133], v[132:133], v[250:251] op_sel_hi:[1,0]
    v_pk_mul_f32 v[134:135], v[134:135], v[250:251] op_sel_hi:[1,0]
    v_cvt_pk_bf16_f32 v232, v132, v133
    v_cvt_pk_bf16_f32 v233, v134, v135
    v_pk_mul_f32 v[140:141], v[140:141], v[250:251] op_sel_hi:[1,0]
    v_pk_mul_f32 v[142:143], v[142:143], v[250:251] op_sel_hi:[1,0]
    v_cvt_pk_bf16_f32 v234, v140, v141
    v_cvt_pk_bf16_f32 v235, v142, v143
    v_permlane16_swap_b32 v212, v214
    v_permlane16_swap_b32 v213, v215
    buffer_store_dwordx4 v[212:215], v14, s[64:67], s77 offen offset:0 sc0 sc1
    v_permlane16_swap_b32 v228, v230
    v_permlane16_swap_b32 v229, v231
    buffer_store_dwordx4 v[228:231], v14, s[64:67], s77 offen offset:512 sc0 sc1
    s_add_u32 s77, s77, 14336
    v_pk_mul_f32 v[144:145], v[144:145], v[248:249] op_sel_hi:[1,0]
    v_pk_mul_f32 v[146:147], v[146:147], v[248:249] op_sel_hi:[1,0]
    v_cvt_pk_bf16_f32 v220, v144, v145
    v_cvt_pk_bf16_f32 v221, v146, v147
    v_pk_mul_f32 v[152:153], v[152:153], v[248:249] op_sel_hi:[1,0]
    v_pk_mul_f32 v[154:155], v[154:155], v[248:249] op_sel_hi:[1,0]
    v_cvt_pk_bf16_f32 v222, v152, v153
    v_cvt_pk_bf16_f32 v223, v154, v155
    v_pk_mul_f32 v[148:149], v[148:149], v[250:251] op_sel_hi:[1,0]
    v_pk_mul_f32 v[150:151], v[150:151], v[250:251] op_sel_hi:[1,0]
    v_cvt_pk_bf16_f32 v236, v148, v149
    v_cvt_pk_bf16_f32 v237, v150, v151
    v_pk_mul_f32 v[156:157], v[156:157], v[250:251] op_sel_hi:[1,0]
    v_pk_mul_f32 v[158:159], v[158:159], v[250:251] op_sel_hi:[1,0]
    v_cvt_pk_bf16_f32 v238, v156, v157
    v_cvt_pk_bf16_f32 v239, v158, v159
    v_permlane16_swap_b32 v216, v218
    v_permlane16_swap_b32 v217, v219
    buffer_store_dwordx4 v[216:219], v14, s[64:67], s77 offen offset:0 sc0 sc1
    v_permlane16_swap_b32 v232, v234
    v_permlane16_swap_b32 v233, v235
    buffer_store_dwordx4 v[232:235], v14, s[64:67], s77 offen offset:512 sc0 sc1
    s_add_u32 s77, s77, 14336
    s_nop 1
    v_permlane16_swap_b32 v220, v222
    v_permlane16_swap_b32 v221, v223
    buffer_store_dwordx4 v[220:223], v14, s[64:67], s77 offen offset:0 sc0 sc1
    v_permlane16_swap_b32 v236, v238
    v_permlane16_swap_b32 v237, v239
    buffer_store_dwordx4 v[236:239], v14, s[64:67], s77 offen offset:512 sc0 sc1
    s_add_u32 s73, s73, 1
    s_cmp_eq_u32 s73, 2
    s_cbranch_scc1 K1_FIN
    v_mov_b32 v16, v48
    v_mov_b32 v17, v49
    v_mov_b32 v18, v50
    v_mov_b32 v19, v51
    v_mov_b32 v20, v52
    v_mov_b32 v21, v53
    v_mov_b32 v22, v54
    v_mov_b32 v23, v55
    v_mov_b32 v24, v56
    v_mov_b32 v25, v57
    v_mov_b32 v26, v58
    v_mov_b32 v27, v59
    v_mov_b32 v28, v60
    v_mov_b32 v29, v61
    v_mov_b32 v30, v62
    v_mov_b32 v31, v63
    v_mov_b32 v32, v64
    v_mov_b32 v33, v65
    v_mov_b32 v34, v66
    v_mov_b32 v35, v67
    v_mov_b32 v36, v68
    v_mov_b32 v37, v69
    v_mov_b32 v38, v70
    v_mov_b32 v39, v71
    v_mov_b32 v40, v72
    v_mov_b32 v41, v73
    v_mov_b32 v42, v74
    v_mov_b32 v43, v75
    v_mov_b32 v44, v76
    v_mov_b32 v45, v77
    v_mov_b32 v46, v78
    v_mov_b32 v47, v79
    s_branch HEAD2
HEAD1:
    ds_read_b128 v[208:211], v8 offset:0
    ds_read_b128 v[212:215], v9 offset:0
    ds_read_b128 v[216:219], v8 offset:1024
    ds_read_b128 v[220:223], v9 offset:1024
    ds_read_b128 v[224:227], v8 offset:4096
    ds_read_b128 v[228:231], v9 offset:4096
    ds_read_b128 v[232:235], v8 offset:5120
    ds_read_b128 v[236:239], v9 offset:5120
    s_waitcnt lgkmcnt(7)
    v_mfma_f32_16x16x32_bf16 v[160:163], v[208:211], v[16:19], 0
    v_mov_b32 v96, 0
    v_mov_b32 v97, 0
    v_mov_b32 v98, 0
    v_mov_b32 v99, 0
    ds_read_b128 v[208:211], v8 offset:8192
    s_waitcnt lgkmcnt(7)
    v_mfma_f32_16x16x32_bf16 v[160:163], v[212:215], v[20:23], v[160:163]
    v_mov_b32 v104, 0
    v_mov_b32 v105, 0
    v_mov_b32 v106, 0
    v_mov_b32 v107, 0
    ds_read_b128 v[212:215], v9 offset:8192
    s_waitcnt lgkmcnt(7)
    v_mfma_f32_16x16x32_bf16 v[160:163], v[216:219], v[24:27], v[160:163]
    v_mov_b32 v112, 0
    v_mov_b32 v113, 0
    v_mov_b32 v114, 0
    v_mov_b32 v115, 0
    ds_read_b128 v[216:219], v8 offset:9216
    s_waitcnt lgkmcnt(7)
    v_mfma_f32_16x16x32_bf16 v[160:163], v[220:223], v[28:31], v[160:163]
    v_mov_b32 v120, 0
    v_mov_b32 v121, 0
    v_mov_b32 v122, 0
    v_mov_b32 v123, 0
    ds_read_b128 v[220:223], v9 offset:9216
    s_waitcnt lgkmcnt(7)
    v_mfma_f32_16x16x32_bf16 v[164:167], v[224:227], v[16:19], 0
    v_mov_b32 v128, 0
    v_mov_b32 v129, 0
    v_mov_b32 v130, 0
    v_mov_b32 v131, 0
    ds_read_b128 v[224:227], v8 offset:12288
    s_waitcnt lgkmcnt(7)
    v_mfma_f32_16x16x32_bf16 v[164:167], v[228:231], v[20:23], v[164:167]
    v_mov_b32 v136, 0
    v_mov_b32 v137, 0
    v_mov_b32 v138, 0
    v_mov_b32 v139, 0
    ds_read_b128 v[228:231], v9 offset:12288
    s_waitcnt lgkmcnt(7)
    v_mfma_f32_16x16x32_bf16 v[164:167], v[232:235], v[24:27], v[164:167]
    v_mov_b32 v144, 0
    v_mov_b32 v145, 0
    v_mov_b32 v146, 0
    v_mov_b32 v147, 0
    ds_read_b128 v[232:235], v8 offset:13312
    s_waitcnt lgkmcnt(7)
    v_mfma_f32_16x16x32_bf16 v[164:167], v[236:239], v[28:31], v[164:167]
    v_mov_b32 v152, 0
    v_mov_b32 v153, 0
    v_mov_b32 v154, 0
    v_mov_b32 v155, 0
    ds_read_b128 v[236:239], v9 offset:13312
    v_mov_b32 v244, 0
    s_nop 3
    v_max3_f32 v248, v160, v161, v162
    v_max3_f32 v248, v248, v163, v164
    v_max3_f32 v248, v248, v165, v166
    v_max_f32 v248, v248, v167
    v_mov_b32 v250, v248
    s_nop 1
    v_permlane16_swap_b32 v248, v250
    v_max_f32 v248, v248, v250
    s_nop 1
    v_mov_b32 v250, v248
    s_nop 1
    v_permlane32_swap_b32 v248, v250
    v_max_f32 v248, v248, v250
    v_sub_f32 v192, 0, v248
    v_sub_f32 v193, 0, v248
    v_sub_f32 v194, 0, v248
    v_sub_f32 v195, 0, v248
    v_pk_add_f32 v[160:161], v[160:161], v[192:193]
    v_pk_add_f32 v[162:163], v[162:163], v[192:193]
    v_pk_add_f32 v[164:165], v[164:165], v[192:193]
    v_pk_add_f32 v[166:167], v[166:167], v[192:193]
    s_waitcnt lgkmcnt(7)
    v_mfma_f32_16x16x32_bf16 v[176:179], v[208:211], v[16:19], v[192:195]
    v_exp_f32 v240, v160
    v_exp_f32 v241, v161
    s_waitcnt lgkmcnt(6)
    v_mfma_f32_16x16x32_bf16 v[176:179], v[212:215], v[20:23], v[176:179]
    v_exp_f32 v242, v162
    v_exp_f32 v243, v163
    s_waitcnt lgkmcnt(5)
    v_mfma_f32_16x16x32_bf16 v[176:179], v[216:219], v[24:27], v[176:179]
    v_add_f32 v246, v240, v241
    v_cvt_pk_bf16_f32 v80, v240, v241
    v_exp_f32 v240, v164
    s_waitcnt lgkmcnt(4)
    v_mfma_f32_16x16x32_bf16 v[176:179], v[220:223], v[28:31], v[176:179]
    v_exp_f32 v241, v165
    v_add_f32 v246, v246, v242
    s_waitcnt lgkmcnt(3)
    v_mfma_f32_16x16x32_bf16 v[180:183], v[224:227], v[16:19], v[192:195]
    v_cvt_pk_bf16_f32 v81, v242, v243
    v_add_f32 v246, v246, v243
    s_waitcnt lgkmcnt(2)
    v_mfma_f32_16x16x32_bf16 v[180:183], v[228:231], v[20:23], v[180:183]
    v_exp_f32 v242, v166
    v_exp_f32 v243, v167
    v_add_f32 v246, v246, v240
    s_waitcnt lgkmcnt(1)
    v_mfma_f32_16x16x32_bf16 v[180:183], v[232:235], v[24:27], v[180:183]
    v_cvt_pk_bf16_f32 v82, v240, v241
    v_add_f32 v246, v246, v241
    s_waitcnt lgkmcnt(0)
    v_mfma_f32_16x16x32_bf16 v[180:183], v[236:239], v[28:31], v[180:183]
    v_add_f32 v246, v246, v242
    v_cvt_pk_bf16_f32 v83, v242, v243
    v_add_f32 v246, v246, v243
    v_add_f32 v244, v244, v246
    s_add_u32 s79, s74, 32768
    s_cmp_ge_u32 s79, s47
    s_cselect_b32 s79, 0, s79
    s_sub_u32 s92, s79, s74
    s_mov_b32 s74, s79
    v_add_u32 v8, s92, v8
    v_add_u32 v9, s92, v9
    s_add_u32 s79, s75, 32768
    s_cmp_ge_u32 s79, s47
    s_cselect_b32 s79, 0, s79
    s_sub_u32 s92, s79, s75
    s_mov_b32 s75, s79
    v_add_u32 v10, s92, v10
    v_add_u32 v11, s92, v11
    v_add_u32 v12, s92, v12
    v_add_u32 v13, s92, v13
    s_waitcnt lgkmcnt(0)
    s_barrier
    ds_read_b128 v[208:211], v8 offset:0
    ds_read_b128 v[212:215], v9 offset:0
    ds_read_b128 v[216:219], v8 offset:1024
    ds_read_b128 v[220:223], v9 offset:1024
    ds_read_b128 v[224:227], v8 offset:4096
    ds_read_b128 v[228:231], v9 offset:4096
    ds_read_b128 v[232:235], v8 offset:5120
    ds_read_b128 v[236:239], v9 offset:5120
    s_mov_b32 s72, 15
ATT_LOOP1:
    s_waitcnt lgkmcnt(4)
    v_mfma_f32_16x16x32_bf16 v[160:163], v[208:211], v[16:19], v[192:195]
    ds_read_b64_tr_b16 v[208:209], v10 offset:0
    ds_read_b64_tr_b16 v[210:211], v10 offset:4096
    v_exp_f32 v240, v176
    v_mfma_f32_16x16x32_bf16 v[160:163], v[212:215], v[20:23], v[160:163]
    ds_read_b64_tr_b16 v[212:213], v11 offset:0
    ds_read_b64_tr_b16 v[214:215], v11 offset:4096
    v_exp_f32 v241, v177
    v_mfma_f32_16x16x32_bf16 v[160:163], v[216:219], v[24:27], v[160:163]
    ds_read_b64_tr_b16 v[216:217], v12 offset:0
    ds_read_b64_tr_b16 v[218:219], v12 offset:4096
    v_exp_f32 v242, v178
    v_mfma_f32_16x16x32_bf16 v[160:163], v[220:223], v[28:31], v[160:163]
    ds_read_b64_tr_b16 v[220:221], v13 offset:0
    ds_read_b64_tr_b16 v[222:223], v13 offset:4096
    s_waitcnt lgkmcnt(8)
    v_mfma_f32_16x16x32_bf16 v[164:167], v[224:227], v[16:19], v[192:195]
    ds_read_b64_tr_b16 v[224:225], v10 offset:1024
    ds_read_b64_tr_b16 v[226:227], v10 offset:5120
    v_exp_f32 v243, v179
    v_mfma_f32_16x16x32_bf16 v[164:167], v[228:231], v[20:23], v[164:167]
    ds_read_b64_tr_b16 v[228:229], v11 offset:1024
    ds_read_b64_tr_b16 v[230:231], v11 offset:5120
    v_add_f32 v246, v240, v241
    v_mfma_f32_16x16x32_bf16 v[164:167], v[232:235], v[24:27], v[164:167]
    ds_read_b64_tr_b16 v[232:233], v12 offset:1024
    ds_read_b64_tr_b16 v[234:235], v12 offset:5120
    v_cvt_pk_bf16_f32 v88, v240, v241
    v_mfma_f32_16x16x32_bf16 v[164:167], v[236:239], v[28:31], v[164:167]
    ds_read_b64_tr_b16 v[236:237], v13 offset:1024
    ds_read_b64_tr_b16 v[238:239], v13 offset:5120
    v_exp_f32 v240, v180
    s_waitcnt lgkmcnt(8)
    v_mfma_f32_16x16x32_bf16 v[96:99], v[208:211], v[80:83], v[96:99]
    v_exp_f32 v241, v181
    v_add_f32 v246, v246, v242
    v_mfma_f32_16x16x32_bf16 v[104:107], v[212:215], v[80:83], v[104:107]
    v_cvt_pk_bf16_f32 v89, v242, v243
    v_add_f32 v246, v246, v243
    v_exp_f32 v242, v182
    v_mfma_f32_16x16x32_bf16 v[112:115], v[216:219], v[80:83], v[112:115]
    v_exp_f32 v243, v183
    v_add_f32 v246, v246, v240
    v_cvt_pk_bf16_f32 v90, v240, v241
    v_mfma_f32_16x16x32_bf16 v[120:123], v[220:223], v[80:83], v[120:123]
    v_add_f32 v246, v246, v241
    s_waitcnt vmcnt(0) lgkmcnt(0)
    s_barrier
    v_mfma_f32_16x16x32_bf16 v[128:131], v[224:227], v[80:83], v[128:131]
    ds_read_b128 v[208:211], v8 offset:8192
    ds_read_b128 v[212:215], v9 offset:8192
    v_add_f32 v246, v246, v242
    v_cvt_pk_bf16_f32 v91, v242, v243
    v_mfma_f32_16x16x32_bf16 v[136:139], v[228:231], v[80:83], v[136:139]
    ds_read_b128 v[216:219], v8 offset:9216
    ds_read_b128 v[220:223], v9 offset:9216
    v_add_f32 v246, v246, v243
    v_cmp_lt_f32 vcc, s78, v246
    v_mfma_f32_16x16x32_bf16 v[144:147], v[232:235], v[80:83], v[144:147]
    ds_read_b128 v[224:227], v8 offset:12288
    ds_read_b128 v[228:231], v9 offset:12288
    v_mfma_f32_16x16x32_bf16 v[152:155], v[236:239], v[80:83], v[152:155]
    ds_read_b128 v[232:235], v8 offset:13312
    ds_read_b128 v[236:239], v9 offset:13312
    s_cbranch_vccnz SLOW1_B1
RET1_B1:
    v_add_f32 v244, v244, v246
    s_waitcnt lgkmcnt(4)
    v_mfma_f32_16x16x32_bf16 v[176:179], v[208:211], v[16:19], v[192:195]
    ds_read_b64_tr_b16 v[208:209], v10 offset:8192
    ds_read_b64_tr_b16 v[210:211], v10 offset:12288
    s_add_u32 s79, s74, 32768
    s_cmp_ge_u32 s79, s47
    v_mfma_f32_16x16x32_bf16 v[176:179], v[212:215], v[20:23], v[176:179]
    ds_read_b64_tr_b16 v[212:213], v11 offset:8192
    ds_read_b64_tr_b16 v[214:215], v11 offset:12288
    s_cselect_b32 s79, 0, s79
    s_sub_u32 s92, s79, s74
    v_exp_f32 v240, v160
    v_mfma_f32_16x16x32_bf16 v[176:179], v[216:219], v[24:27], v[176:179]
    ds_read_b64_tr_b16 v[216:217], v12 offset:8192
    ds_read_b64_tr_b16 v[218:219], v12 offset:12288
    s_mov_b32 s74, s79
    v_add_u32 v8, s92, v8
    v_mfma_f32_16x16x32_bf16 v[176:179], v[220:223], v[28:31], v[176:179]
    ds_read_b64_tr_b16 v[220:221], v13 offset:8192
    ds_read_b64_tr_b16 v[222:223], v13 offset:12288
    v_add_u32 v9, s92, v9
    v_exp_f32 v241, v161
    s_waitcnt lgkmcnt(8)
    v_mfma_f32_16x16x32_bf16 v[180:183], v[224:227], v[16:19], v[192:195]
    ds_read_b64_tr_b16 v[224:225], v10 offset:9216
    ds_read_b64_tr_b16 v[226:227], v10 offset:13312
    v_exp_f32 v242, v162
    v_mfma_f32_16x16x32_bf16 v[180:183], v[228:231], v[20:23], v[180:183]
    ds_read_b64_tr_b16 v[228:229], v11 offset:9216
    ds_read_b64_tr_b16 v[230:231], v11 offset:13312
    v_exp_f32 v243, v163
    v_add_f32 v246, v240, v241
    v_mfma_f32_16x16x32_bf16 v[180:183], v[232:235], v[24:27], v[180:183]
    ds_read_b64_tr_b16 v[232:233], v12 offset:9216
    ds_read_b64_tr_b16 v[234:235], v12 offset:13312
    v_cvt_pk_bf16_f32 v80, v240, v241
    v_exp_f32 v240, v164
    v_mfma_f32_16x16x32_bf16 v[180:183], v[236:239], v[28:31], v[180:183]
    ds_read_b64_tr_b16 v[236:237], v13 offset:9216
    ds_read_b64_tr_b16 v[238:239], v13 offset:13312
    v_exp_f32 v241, v165
    s_waitcnt lgkmcnt(8)
    v_mfma_f32_16x16x32_bf16 v[96:99], v[208:211], v[88:91], v[96:99]
    s_add_u32 s79, s75, 32768
    s_cmp_ge_u32 s79, s47
    v_add_f32 v246, v246, v242
    v_cvt_pk_bf16_f32 v81, v242, v243
    v_mfma_f32_16x16x32_bf16 v[104:107], v[212:215], v[88:91], v[104:107]
    s_cselect_b32 s79, 0, s79
    s_sub_u32 s92, s79, s75
    v_add_f32 v246, v246, v243
    v_exp_f32 v242, v166
    v_mfma_f32_16x16x32_bf16 v[112:115], v[216:219], v[88:91], v[112:115]
    s_mov_b32 s75, s79
    v_add_u32 v10, s92, v10
    v_exp_f32 v243, v167
    v_add_f32 v246, v246, v240
    v_mfma_f32_16x16x32_bf16 v[120:123], v[220:223], v[88:91], v[120:123]
    v_add_u32 v11, s92, v11
    v_add_u32 v12, s92, v12
    v_cvt_pk_bf16_f32 v82, v240, v241
    s_waitcnt vmcnt(0) lgkmcnt(0)
    s_barrier
    v_mfma_f32_16x16x32_bf16 v[128:131], v[224:227], v[88:91], v[128:131]
    ds_read_b128 v[208:211], v8 offset:0
    ds_read_b128 v[212:215], v9 offset:0
    v_add_u32 v13, s92, v13
    v_add_f32 v246, v246, v241
    v_add_f32 v246, v246, v242
    v_mfma_f32_16x16x32_bf16 v[136:139], v[228:231], v[88:91], v[136:139]
    ds_read_b128 v[216:219], v8 offset:1024
    ds_read_b128 v[220:223], v9 offset:1024
    v_cvt_pk_bf16_f32 v83, v242, v243
    v_add_f32 v246, v246, v243
    v_mfma_f32_16x16x32_bf16 v[144:147], v[232:235], v[88:91], v[144:147]
    ds_read_b128 v[224:227], v8 offset:4096
    ds_read_b128 v[228:231], v9 offset:4096
    s_sub_u32 s72, s72, 1
    s_cmp_lg_u32 s72, 0
    v_cmp_lt_f32 vcc, s78, v246
    v_mfma_f32_16x16x32_bf16 v[152:155], v[236:239], v[88:91], v[152:155]
    ds_read_b128 v[232:235], v8 offset:5120
    ds_read_b128 v[236:239], v9 offset:5120
    s_cbranch_vccnz SLOW0_B1
RET0_B1:
    v_add_f32 v244, v244, v246
    s_cbranch_scc1 ATT_LOOP1
    s_lshl_b32 s77, s73, 16
    ds_read_b64_tr_b16 v[208:209], v10 offset:0
    ds_read_b64_tr_b16 v[210:211], v10 offset:4096
    ds_read_b64_tr_b16 v[212:213], v11 offset:0
    ds_read_b64_tr_b16 v[214:215], v11 offset:4096
    ds_read_b64_tr_b16 v[216:217], v12 offset:0
    ds_read_b64_tr_b16 v[218:219], v12 offset:4096
    s_waitcnt lgkmcnt(4)
    v_mfma_f32_16x16x32_bf16 v[96:99], v[208:211], v[80:83], v[96:99]
    v_exp_f32 v240, v176
    v_exp_f32 v241, v177
    ds_read_b64_tr_b16 v[220:221], v13 offset:0
    ds_read_b64_tr_b16 v[222:223], v13 offset:4096
    ds_read_b64_tr_b16 v[224:225], v10 offset:1024
    ds_read_b64_tr_b16 v[226:227], v10 offset:5120
    ds_read_b64_tr_b16 v[228:229], v11 offset:1024
    ds_read_b64_tr_b16 v[230:231], v11 offset:5120
    ds_read_b64_tr_b16 v[232:233], v12 offset:1024
    ds_read_b64_tr_b16 v[234:235], v12 offset:5120
    ds_read_b64_tr_b16 v[236:237], v13 offset:1024
    ds_read_b64_tr_b16 v[238:239], v13 offset:5120
    s_waitcnt lgkmcnt(12)
    v_mfma_f32_16x16x32_bf16 v[104:107], v[212:215], v[80:83], v[104:107]
    v_exp_f32 v242, v178
    v_exp_f32 v243, v179
    v_add_f32 v246, v240, v241
    s_waitcnt lgkmcnt(10)
    v_mfma_f32_16x16x32_bf16 v[112:115], v[216:219], v[80:83], v[112:115]
    v_cvt_pk_bf16_f32 v88, v240, v241
    v_exp_f32 v240, v180
    s_waitcnt lgkmcnt(8)
    v_mfma_f32_16x16x32_bf16 v[120:123], v[220:223], v[80:83], v[120:123]
    v_exp_f32 v241, v181
    v_add_f32 v246, v246, v242
    v_cvt_pk_bf16_f32 v89, v242, v243
    s_waitcnt lgkmcnt(0)
    s_barrier
    v_mfma_f32_16x16x32_bf16 v[128:131], v[224:227], v[80:83], v[128:131]
    v_add_f32 v246, v246, v243
    v_exp_f32 v242, v182
    ds_read_b64_tr_b16 v[208:209], v10 offset:8192
    ds_read_b64_tr_b16 v[210:211], v10 offset:12288
    ds_read_b64_tr_b16 v[212:213], v11 offset:8192
    ds_read_b64_tr_b16 v[214:215], v11 offset:12288
    ds_read_b64_tr_b16 v[216:217], v12 offset:8192
    ds_read_b64_tr_b16 v[218:219], v12 offset:12288
    ds_read_b64_tr_b16 v[220:221], v13 offset:8192
    ds_read_b64_tr_b16 v[222:223], v13 offset:12288
    ds_read_b64_tr_b16 v[224:225], v10 offset:9216
    ds_read_b64_tr_b16 v[226:227], v10 offset:13312
    v_mfma_f32_16x16x32_bf16 v[136:139], v[228:231], v[80:83], v[136:139]
    v_exp_f32 v243, v183
    v_add_f32 v246, v246, v240
    v_cvt_pk_bf16_f32 v90, v240, v241
    ds_read_b64_tr_b16 v[228:229], v11 offset:9216
    ds_read_b64_tr_b16 v[230:231], v11 offset:13312
    v_mfma_f32_16x16x32_bf16 v[144:147], v[232:235], v[80:83], v[144:147]
    v_add_f32 v246, v246, v241
    v_add_f32 v246, v246, v242
    ds_read_b64_tr_b16 v[232:233], v12 offset:9216
    ds_read_b64_tr_b16 v[234:235], v12 offset:13312
    v_mfma_f32_16x16x32_bf16 v[152:155], v[236:239], v[80:83], v[152:155]
    v_cvt_pk_bf16_f32 v91, v242, v243
    v_add_f32 v246, v246, v243
    v_cmp_lt_f32 vcc, s78, v246
    s_cbranch_vccnz SLOW1_E1
RET1_E1:
    v_add_f32 v244, v244, v246
    s_nop 0
    s_waitcnt lgkmcnt(12)
    v_mfma_f32_16x16x32_bf16 v[96:99], v[208:211], v[88:91], v[96:99]
    v_mov_b32 v240, v244
    s_nop 1
    v_permlane16_swap_b32 v244, v240
    ds_read_b64_tr_b16 v[236:237], v13 offset:9216
    ds_read_b64_tr_b16 v[238:239], v13 offset:13312
    s_waitcnt lgkmcnt(12)
    v_mfma_f32_16x16x32_bf16 v[104:107], v[212:215], v[88:91], v[104:107]
    v_add_f32 v244, v244, v240
    s_nop 1
    v_mov_b32 v240, v244
    s_waitcnt lgkmcnt(10)
    v_mfma_f32_16x16x32_bf16 v[112:115], v[216:219], v[88:91], v[112:115]
    s_nop 1
    v_permlane32_swap_b32 v244, v240
    v_add_f32 v244, v244, v240
    s_waitcnt lgkmcnt(8)
    v_mfma_f32_16x16x32_bf16 v[120:123], v[220:223], v[88:91], v[120:123]
    v_rcp_f32 v248, v244
    s_nop 0
    s_waitcnt lgkmcnt(6)
    v_mfma_f32_16x16x32_bf16 v[128:131], v[224:227], v[88:91], v[128:131]
    s_waitcnt lgkmcnt(4)
    v_mfma_f32_16x16x32_bf16 v[136:139], v[228:231], v[88:91], v[136:139]
    s_waitcnt lgkmcnt(2)
    v_mfma_f32_16x16x32_bf16 v[144:147], v[232:235], v[88:91], v[144:147]
    s_waitcnt lgkmcnt(0)
    v_mfma_f32_16x16x32_bf16 v[152:155], v[236:239], v[88:91], v[152:155]
    v_pk_mul_f32 v[96:97], v[96:97], v[248:249] op_sel_hi:[1,0]
    v_pk_mul_f32 v[98:99], v[98:99], v[248:249] op_sel_hi:[1,0]
    v_cvt_pk_bf16_f32 v208, v96, v97
    v_cvt_pk_bf16_f32 v209, v98, v99
    v_pk_mul_f32 v[104:105], v[104:105], v[248:249] op_sel_hi:[1,0]
    v_pk_mul_f32 v[106:107], v[106:107], v[248:249] op_sel_hi:[1,0]
    v_cvt_pk_bf16_f32 v210, v104, v105
    v_cvt_pk_bf16_f32 v211, v106, v107
    v_pk_mul_f32 v[112:113], v[112:113], v[248:249] op_sel_hi:[1,0]
    v_pk_mul_f32 v[114:115], v[114:115], v[248:249] op_sel_hi:[1,0]
    v_cvt_pk_bf16_f32 v212, v112, v113
    v_cvt_pk_bf16_f32 v213, v114, v115
    v_pk_mul_f32 v[120:121], v[120:121], v[248:249] op_sel_hi:[1,0]
    v_pk_mul_f32 v[122:123], v[122:123], v[248:249] op_sel_hi:[1,0]
    v_cvt_pk_bf16_f32 v214, v120, v121
    v_cvt_pk_bf16_f32 v215, v122, v123
    v_permlane16_swap_b32 v208, v210
    v_permlane16_swap_b32 v209, v211
    buffer_store_dwordx4 v[208:211], v14, s[64:67], s77 offen offset:0 sc0 sc1
    s_add_u32 s77, s77, 14336
    v_pk_mul_f32 v[128:129], v[128:129], v[248:249] op_sel_hi:[1,0]
    v_pk_mul_f32 v[130:131], v[130:131], v[248:249] op_sel_hi:[1,0]
    v_cvt_pk_bf16_f32 v216, v128, v129
    v_cvt_pk_bf16_f32 v217, v130, v131
    v_pk_mul_f32 v[136:137], v[136:137], v[248:249] op_sel_hi:[1,0]
    v_pk_mul_f32 v[138:139], v[138:139], v[248:249] op_sel_hi:[1,0]
    v_cvt_pk_bf16_f32 v218, v136, v137
    v_cvt_pk_bf16_f32 v219, v138, v139
    v_permlane16_swap_b32 v212, v214
    v_permlane16_swap_b32 v213, v215
    buffer_store_dwordx4 v[212:215], v14, s[64:67], s77 offen offset:0 sc0 sc1
    s_add_u32 s77, s77, 14336
    v_pk_mul_f32 v[144:145], v[144:145], v[248:249] op_sel_hi:[1,0]
    v_pk_mul_f32 v[146:147], v[146:147], v[248:249] op_sel_hi:[1,0]
    v_cvt_pk_bf16_f32 v220, v144, v145
    v_cvt_pk_bf16_f32 v221, v146, v147
    v_pk_mul_f32 v[152:153], v[152:153], v[248:249] op_sel_hi:[1,0]
    v_pk_mul_f32 v[154:155], v[154:155], v[248:249] op_sel_hi:[1,0]
    v_cvt_pk_bf16_f32 v222, v152, v153
    v_cvt_pk_bf16_f32 v223, v154, v155
    v_permlane16_swap_b32 v216, v218
    v_permlane16_swap_b32 v217, v219
    buffer_store_dwordx4 v[216:219], v14, s[64:67], s77 offen offset:0 sc0 sc1
    s_add_u32 s77, s77, 14336
    s_nop 1
    v_permlane16_swap_b32 v220, v222
    v_permlane16_swap_b32 v221, v223
    buffer_store_dwordx4 v[220:223], v14, s[64:67], s77 offen offset:0 sc0 sc1
    s_add_u32 s73, s73, 1
    s_cmp_eq_u32 s73, 2
    s_cbranch_scc1 K1_FIN
    v_mov_b32 v16, v48
    v_mov_b32 v17, v49
    v_mov_b32 v18, v50
    v_mov_b32 v19, v51
    v_mov_b32 v20, v52
    v_mov_b32 v21, v53
    v_mov_b32 v22, v54
    v_mov_b32 v23, v55
    v_mov_b32 v24, v56
    v_mov_b32 v25, v57
    v_mov_b32 v26, v58
    v_mov_b32 v27, v59
    v_mov_b32 v28, v60
    v_mov_b32 v29, v61
    v_mov_b32 v30, v62
    v_mov_b32 v31, v63
    s_branch HEAD1
SLOW0_B2:
    s_nop 15
    v_max3_f32 v248, v160, v161, v162
    v_max3_f32 v248, v248, v163, v164
    v_max3_f32 v248, v248, v165, v166
    v_max3_f32 v248, v248, v167, 0
    v_mov_b32 v250, v248
    s_nop 1
    v_permlane16_swap_b32 v248, v250
    v_max_f32 v248, v248, v250
    s_nop 1
    v_mov_b32 v250, v248
    s_nop 1
    v_permlane32_swap_b32 v248, v250
    v_max_f32 v248, v248, v250
    v_exp_f32 v250, -v248
    v_sub_f32 v160, v160, v248
    v_sub_f32 v176, v176, v248
    v_sub_f32 v161, v161, v248
    v_sub_f32 v177, v177, v248
    v_sub_f32 v162, v162, v248
    v_sub_f32 v178, v178, v248
    v_sub_f32 v163, v163, v248
    v_sub_f32 v179, v179, v248
    v_sub_f32 v164, v164, v248
    v_sub_f32 v180, v180, v248
    v_sub_f32 v165, v165, v248
    v_sub_f32 v181, v181, v248
    v_sub_f32 v166, v166, v248
    v_sub_f32 v182, v182, v248
    v_sub_f32 v167, v167, v248
    v_sub_f32 v183, v183, v248
    v_sub_f32 v192, v192, v248
    v_sub_f32 v193, v193, v248
    v_sub_f32 v194, v194, v248
    v_sub_f32 v195, v195, v248
    v_pk_mul_f32 v[96:97], v[96:97], v[250:251] op_sel_hi:[1,0]
    v_pk_mul_f32 v[98:99], v[98:99], v[250:251] op_sel_hi:[1,0]
    v_pk_mul_f32 v[104:105], v[104:105], v[250:251] op_sel_hi:[1,0]
    v_pk_mul_f32 v[106:107], v[106:107], v[250:251] op_sel_hi:[1,0]
    v_pk_mul_f32 v[112:113], v[112:113], v[250:251] op_sel_hi:[1,0]
    v_pk_mul_f32 v[114:115], v[114:115], v[250:251] op_sel_hi:[1,0]
    v_pk_mul_f32 v[120:121], v[120:121], v[250:251] op_sel_hi:[1,0]
    v_pk_mul_f32 v[122:123], v[122:123], v[250:251] op_sel_hi:[1,0]
    v_pk_mul_f32 v[128:129], v[128:129], v[250:251] op_sel_hi:[1,0]
    v_pk_mul_f32 v[130:131], v[130:131], v[250:251] op_sel_hi:[1,0]
    v_pk_mul_f32 v[136:137], v[136:137], v[250:251] op_sel_hi:[1,0]
    v_pk_mul_f32 v[138:139], v[138:139], v[250:251] op_sel_hi:[1,0]
    v_pk_mul_f32 v[144:145], v[144:145], v[250:251] op_sel_hi:[1,0]
    v_pk_mul_f32 v[146:147], v[146:147], v[250:251] op_sel_hi:[1,0]
    v_pk_mul_f32 v[152:153], v[152:153], v[250:251] op_sel_hi:[1,0]
    v_pk_mul_f32 v[154:155], v[154:155], v[250:251] op_sel_hi:[1,0]
    v_mul_f32 v244, v244, v250
    v_max3_f32 v248, v168, v169, v170
    v_max3_f32 v248, v248, v171, v172
    v_max3_f32 v248, v248, v173, v174
    v_max3_f32 v248, v248, v175, 0
    v_mov_b32 v250, v248
    s_nop 1
    v_permlane16_swap_b32 v248, v250
    v_max_f32 v248, v248, v250
    s_nop 1
    v_mov_b32 v250, v248
    s_nop 1
    v_permlane32_swap_b32 v248, v250
    v_max_f32 v248, v248, v250
    v_exp_f32 v250, -v248
    v_sub_f32 v168, v168, v248
    v_sub_f32 v184, v184, v248
    v_sub_f32 v169, v169, v248
    v_sub_f32 v185, v185, v248
    v_sub_f32 v170, v170, v248
    v_sub_f32 v186, v186, v248
    v_sub_f32 v171, v171, v248
    v_sub_f32 v187, v187, v248
    v_sub_f32 v172, v172, v248
    v_sub_f32 v188, v188, v248
    v_sub_f32 v173, v173, v248
    v_sub_f32 v189, v189, v248
    v_sub_f32 v174, v174, v248
    v_sub_f32 v190, v190, v248
    v_sub_f32 v175, v175, v248
    v_sub_f32 v191, v191, v248
    v_sub_f32 v196, v196, v248
    v_sub_f32 v197, v197, v248
    v_sub_f32 v198, v198, v248
    v_sub_f32 v199, v199, v248
    v_pk_mul_f32 v[100:101], v[100:101], v[250:251] op_sel_hi:[1,0]
    v_pk_mul_f32 v[102:103], v[102:103], v[250:251] op_sel_hi:[1,0]
    v_pk_mul_f32 v[108:109], v[108:109], v[250:251] op_sel_hi:[1,0]
    v_pk_mul_f32 v[110:111], v[110:111], v[250:251] op_sel_hi:[1,0]
    v_pk_mul_f32 v[116:117], v[116:117], v[250:251] op_sel_hi:[1,0]
    v_pk_mul_f32 v[118:119], v[118:119], v[250:251] op_sel_hi:[1,0]
    v_pk_mul_f32 v[124:125], v[124:125], v[250:251] op_sel_hi:[1,0]
    v_pk_mul_f32 v[126:127], v[126:127], v[250:251] op_sel_hi:[1,0]
    v_pk_mul_f32 v[132:133], v[132:133], v[250:251] op_sel_hi:[1,0]
    v_pk_mul_f32 v[134:135], v[134:135], v[250:251] op_sel_hi:[1,0]
    v_pk_mul_f32 v[140:141], v[140:141], v[250:251] op_sel_hi:[1,0]
    v_pk_mul_f32 v[142:143], v[142:143], v[250:251] op_sel_hi:[1,0]
    v_pk_mul_f32 v[148:149], v[148:149], v[250:251] op_sel_hi:[1,0]
    v_pk_mul_f32 v[150:151], v[150:151], v[250:251] op_sel_hi:[1,0]
    v_pk_mul_f32 v[156:157], v[156:157], v[250:251] op_sel_hi:[1,0]
    v_pk_mul_f32 v[158:159], v[158:159], v[250:251] op_sel_hi:[1,0]
    v_mul_f32 v245, v245, v250
    v_exp_f32 v240, v160
    v_exp_f32 v241, v161
    v_exp_f32 v242, v162
    v_exp_f32 v243, v163
    v_add_f32 v246, v240, v241
    v_cvt_pk_bf16_f32 v80, v240, v241
    v_exp_f32 v240, v164
    v_exp_f32 v241, v165
    v_add_f32 v246, v246, v242
    v_cvt_pk_bf16_f32 v81, v242, v243
    v_add_f32 v246, v246, v243
    v_exp_f32 v242, v166
    v_exp_f32 v243, v167
    v_add_f32 v246, v246, v240
    v_cvt_pk_bf16_f32 v82, v240, v241
    v_add_f32 v246, v246, v241
    v_exp_f32 v240, v168
    v_exp_f32 v241, v169
    v_add_f32 v246, v246, v242
    v_cvt_pk_bf16_f32 v83, v242, v243
    v_add_f32 v246, v246, v243
    v_exp_f32 v242, v170
    v_exp_f32 v243, v171
    v_add_f32 v247, v240, v241
    v_cvt_pk_bf16_f32 v84, v240, v241
    v_exp_f32 v240, v172
    v_exp_f32 v241, v173
    v_add_f32 v247, v247, v242
    v_cvt_pk_bf16_f32 v85, v242, v243
    v_add_f32 v247, v247, v243
    v_exp_f32 v242, v174
    v_exp_f32 v243, v175
    v_add_f32 v247, v247, v240
    v_cvt_pk_bf16_f32 v86, v240, v241
    v_add_f32 v247, v247, v241
    v_add_f32 v247, v247, v242
    v_cvt_pk_bf16_f32 v87, v242, v243
    v_add_f32 v247, v247, v243
    s_nop 1
    s_branch RET0_B2
SLOW1_B2:
    s_nop 15
    v_max3_f32 v248, v176, v177, v178
    v_max3_f32 v248, v248, v179, v180
    v_max3_f32 v248, v248, v181, v182
    v_max3_f32 v248, v248, v183, 0
    v_mov_b32 v250, v248
    s_nop 1
    v_permlane16_swap_b32 v248, v250
    v_max_f32 v248, v248, v250
    s_nop 1
    v_mov_b32 v250, v248
    s_nop 1
    v_permlane32_swap_b32 v248, v250
    v_max_f32 v248, v248, v250
    v_exp_f32 v250, -v248
    v_sub_f32 v176, v176, v248
    v_sub_f32 v160, v160, v248
    v_sub_f32 v177, v177, v248
    v_sub_f32 v161, v161, v248
    v_sub_f32 v178, v178, v248
    v_sub_f32 v162, v162, v248
    v_sub_f32 v179, v179, v248
    v_sub_f32 v163, v163, v248
    v_sub_f32 v180, v180, v248
    v_sub_f32 v164, v164, v248
    v_sub_f32 v181, v181, v248
    v_sub_f32 v165, v165, v248
    v_sub_f32 v182, v182, v248
    v_sub_f32 v166, v166, v248
    v_sub_f32 v183, v183, v248
    v_sub_f32 v167, v167, v248
    v_sub_f32 v192, v192, v248
    v_sub_f32 v193, v193, v248
    v_sub_f32 v194, v194, v248
    v_sub_f32 v195, v195, v248
    v_pk_mul_f32 v[96:97], v[96:97], v[250:251] op_sel_hi:[1,0]
    v_pk_mul_f32 v[98:99], v[98:99], v[250:251] op_sel_hi:[1,0]
    v_pk_mul_f32 v[104:105], v[104:105], v[250:251] op_sel_hi:[1,0]
    v_pk_mul_f32 v[106:107], v[106:107], v[250:251] op_sel_hi:[1,0]
    v_pk_mul_f32 v[112:113], v[112:113], v[250:251] op_sel_hi:[1,0]
    v_pk_mul_f32 v[114:115], v[114:115], v[250:251] op_sel_hi:[1,0]
    v_pk_mul_f32 v[120:121], v[120:121], v[250:251] op_sel_hi:[1,0]
    v_pk_mul_f32 v[122:123], v[122:123], v[250:251] op_sel_hi:[1,0]
    v_pk_mul_f32 v[128:129], v[128:129], v[250:251] op_sel_hi:[1,0]
    v_pk_mul_f32 v[130:131], v[130:131], v[250:251] op_sel_hi:[1,0]
    v_pk_mul_f32 v[136:137], v[136:137], v[250:251] op_sel_hi:[1,0]
    v_pk_mul_f32 v[138:139], v[138:139], v[250:251] op_sel_hi:[1,0]
    v_pk_mul_f32 v[144:145], v[144:145], v[250:251] op_sel_hi:[1,0]
    v_pk_mul_f32 v[146:147], v[146:147], v[250:251] op_sel_hi:[1,0]
    v_pk_mul_f32 v[152:153], v[152:153], v[250:251] op_sel_hi:[1,0]
    v_pk_mul_f32 v[154:155], v[154:155], v[250:251] op_sel_hi:[1,0]
    v_mul_f32 v244, v244, v250
    v_max3_f32 v248, v184, v185, v186
    v_max3_f32 v248, v248, v187, v188
    v_max3_f32 v248, v248, v189, v190
    v_max3_f32 v248, v248, v191, 0
    v_mov_b32 v250, v248
    s_nop 1
    v_permlane16_swap_b32 v248, v250
    v_max_f32 v248, v248, v250
    s_nop 1
    v_mov_b32 v250, v248
    s_nop 1
    v_permlane32_swap_b32 v248, v250
    v_max_f32 v248, v248, v250
    v_exp_f32 v250, -v248
    v_sub_f32 v184, v184, v248
    v_sub_f32 v168, v168, v248
    v_sub_f32 v185, v185, v248
    v_sub_f32 v169, v169, v248
    v_sub_f32 v186, v186, v248
    v_sub_f32 v170, v170, v248
    v_sub_f32 v187, v187, v248
    v_sub_f32 v171, v171, v248
    v_sub_f32 v188, v188, v248
    v_sub_f32 v172, v172, v248
    v_sub_f32 v189, v189, v248
    v_sub_f32 v173, v173, v248
    v_sub_f32 v190, v190, v248
    v_sub_f32 v174, v174, v248
    v_sub_f32 v191, v191, v248
    v_sub_f32 v175, v175, v248
    v_sub_f32 v196, v196, v248
    v_sub_f32 v197, v197, v248
    v_sub_f32 v198, v198, v248
    v_sub_f32 v199, v199, v248
    v_pk_mul_f32 v[100:101], v[100:101], v[250:251] op_sel_hi:[1,0]
    v_pk_mul_f32 v[102:103], v[102:103], v[250:251] op_sel_hi:[1,0]
    v_pk_mul_f32 v[108:109], v[108:109], v[250:251] op_sel_hi:[1,0]
    v_pk_mul_f32 v[110:111], v[110:111], v[250:251] op_sel_hi:[1,0]
    v_pk_mul_f32 v[116:117], v[116:117], v[250:251] op_sel_hi:[1,0]
    v_pk_mul_f32 v[118:119], v[118:119], v[250:251] op_sel_hi:[1,0]
    v_pk_mul_f32 v[124:125], v[124:125], v[250:251] op_sel_hi:[1,0]
    v_pk_mul_f32 v[126:127], v[126:127], v[250:251] op_sel_hi:[1,0]
    v_pk_mul_f32 v[132:133], v[132:133], v[250:251] op_sel_hi:[1,0]
    v_pk_mul_f32 v[134:135], v[134:135], v[250:251] op_sel_hi:[1,0]
    v_pk_mul_f32 v[140:141], v[140:141], v[250:251] op_sel_hi:[1,0]
    v_pk_mul_f32 v[142:143], v[142:143], v[250:251] op_sel_hi:[1,0]
    v_pk_mul_f32 v[148:149], v[148:149], v[250:251] op_sel_hi:[1,0]
    v_pk_mul_f32 v[150:151], v[150:151], v[250:251] op_sel_hi:[1,0]
    v_pk_mul_f32 v[156:157], v[156:157], v[250:251] op_sel_hi:[1,0]
    v_pk_mul_f32 v[158:159], v[158:159], v[250:251] op_sel_hi:[1,0]
    v_mul_f32 v245, v245, v250
    v_exp_f32 v240, v176
    v_exp_f32 v241, v177
    v_exp_f32 v242, v178
    v_exp_f32 v243, v179
    v_add_f32 v246, v240, v241
    v_cvt_pk_bf16_f32 v88, v240, v241
    v_exp_f32 v240, v180
    v_exp_f32 v241, v181
    v_add_f32 v246, v246, v242
    v_cvt_pk_bf16_f32 v89, v242, v243
    v_add_f32 v246, v246, v243
    v_exp_f32 v242, v182
    v_exp_f32 v243, v183
    v_add_f32 v246, v246, v240
    v_cvt_pk_bf16_f32 v90, v240, v241
    v_add_f32 v246, v246, v241
    v_exp_f32 v240, v184
    v_exp_f32 v241, v185
    v_add_f32 v246, v246, v242
    v_cvt_pk_bf16_f32 v91, v242, v243
    v_add_f32 v246, v246, v243
    v_exp_f32 v242, v186
    v_exp_f32 v243, v187
    v_add_f32 v247, v240, v241
    v_cvt_pk_bf16_f32 v92, v240, v241
    v_exp_f32 v240, v188
    v_exp_f32 v241, v189
    v_add_f32 v247, v247, v242
    v_cvt_pk_bf16_f32 v93, v242, v243
    v_add_f32 v247, v247, v243
    v_exp_f32 v242, v190
    v_exp_f32 v243, v191
    v_add_f32 v247, v247, v240
    v_cvt_pk_bf16_f32 v94, v240, v241
    v_add_f32 v247, v247, v241
    v_add_f32 v247, v247, v242
    v_cvt_pk_bf16_f32 v95, v242, v243
    v_add_f32 v247, v247, v243
    s_nop 1
    s_branch RET1_B2
SLOW1_E2:
    s_nop 15
    v_max3_f32 v248, v176, v177, v178
    v_max3_f32 v248, v248, v179, v180
    v_max3_f32 v248, v248, v181, v182
    v_max3_f32 v248, v248, v183, 0
    v_mov_b32 v250, v248
    s_nop 1
    v_permlane16_swap_b32 v248, v250
    v_max_f32 v248, v248, v250
    s_nop 1
    v_mov_b32 v250, v248
    s_nop 1
    v_permlane32_swap_b32 v248, v250
    v_max_f32 v248, v248, v250
    v_exp_f32 v250, -v248
    v_sub_f32 v176, v176, v248
    v_sub_f32 v160, v160, v248
    v_sub_f32 v177, v177, v248
    v_sub_f32 v161, v161, v248
    v_sub_f32 v178, v178, v248
    v_sub_f32 v162, v162, v248
    v_sub_f32 v179, v179, v248
    v_sub_f32 v163, v163, v248
    v_sub_f32 v180, v180, v248
    v_sub_f32 v164, v164, v248
    v_sub_f32 v181, v181, v248
    v_sub_f32 v165, v165, v248
    v_sub_f32 v182, v182, v248
    v_sub_f32 v166, v166, v248
    v_sub_f32 v183, v183, v248
    v_sub_f32 v167, v167, v248
    v_sub_f32 v192, v192, v248
    v_sub_f32 v193, v193, v248
    v_sub_f32 v194, v194, v248
    v_sub_f32 v195, v195, v248
    v_pk_mul_f32 v[96:97], v[96:97], v[250:251] op_sel_hi:[1,0]
    v_pk_mul_f32 v[98:99], v[98:99], v[250:251] op_sel_hi:[1,0]
    v_pk_mul_f32 v[104:105], v[104:105], v[250:251] op_sel_hi:[1,0]
    v_pk_mul_f32 v[106:107], v[106:107], v[250:251] op_sel_hi:[1,0]
    v_pk_mul_f32 v[112:113], v[112:113], v[250:251] op_sel_hi:[1,0]
    v_pk_mul_f32 v[114:115], v[114:115], v[250:251] op_sel_hi:[1,0]
    v_pk_mul_f32 v[120:121], v[120:121], v[250:251] op_sel_hi:[1,0]
    v_pk_mul_f32 v[122:123], v[122:123], v[250:251] op_sel_hi:[1,0]
    v_pk_mul_f32 v[128:129], v[128:129], v[250:251] op_sel_hi:[1,0]
    v_pk_mul_f32 v[130:131], v[130:131], v[250:251] op_sel_hi:[1,0]
    v_pk_mul_f32 v[136:137], v[136:137], v[250:251] op_sel_hi:[1,0]
    v_pk_mul_f32 v[138:139], v[138:139], v[250:251] op_sel_hi:[1,0]
    v_pk_mul_f32 v[144:145], v[144:145], v[250:251] op_sel_hi:[1,0]
    v_pk_mul_f32 v[146:147], v[146:147], v[250:251] op_sel_hi:[1,0]
    v_pk_mul_f32 v[152:153], v[152:153], v[250:251] op_sel_hi:[1,0]
    v_pk_mul_f32 v[154:155], v[154:155], v[250:251] op_sel_hi:[1,0]
    v_mul_f32 v244, v244, v250
    v_max3_f32 v248, v184, v185, v186
    v_max3_f32 v248, v248, v187, v188
    v_max3_f32 v248, v248, v189, v190
    v_max3_f32 v248, v248, v191, 0
    v_mov_b32 v250, v248
    s_nop 1
    v_permlane16_swap_b32 v248, v250
    v_max_f32 v248, v248, v250
    s_nop 1
    v_mov_b32 v250, v248
    s_nop 1
    v_permlane32_swap_b32 v248, v250
    v_max_f32 v248, v248, v250
    v_exp_f32 v250, -v248
    v_sub_f32 v184, v184, v248
    v_sub_f32 v168, v168, v248
    v_sub_f32 v185, v185, v248
    v_sub_f32 v169, v169, v248
    v_sub_f32 v186, v186, v248
    v_sub_f32 v170, v170, v248
    v_sub_f32 v187, v187, v248
    v_sub_f32 v171, v171, v248
    v_sub_f32 v188, v188, v248
    v_sub_f32 v172, v172, v248
    v_sub_f32 v189, v189, v248
    v_sub_f32 v173, v173, v248
    v_sub_f32 v190, v190, v248
    v_sub_f32 v174, v174, v248
    v_sub_f32 v191, v191, v248
    v_sub_f32 v175, v175, v248
    v_sub_f32 v196, v196, v248
    v_sub_f32 v197, v197, v248
    v_sub_f32 v198, v198, v248
    v_sub_f32 v199, v199, v248
    v_pk_mul_f32 v[100:101], v[100:101], v[250:251] op_sel_hi:[1,0]
    v_pk_mul_f32 v[102:103], v[102:103], v[250:251] op_sel_hi:[1,0]
    v_pk_mul_f32 v[108:109], v[108:109], v[250:251] op_sel_hi:[1,0]
    v_pk_mul_f32 v[110:111], v[110:111], v[250:251] op_sel_hi:[1,0]
    v_pk_mul_f32 v[116:117], v[116:117], v[250:251] op_sel_hi:[1,0]
    v_pk_mul_f32 v[118:119], v[118:119], v[250:251] op_sel_hi:[1,0]
    v_pk_mul_f32 v[124:125], v[124:125], v[250:251] op_sel_hi:[1,0]
    v_pk_mul_f32 v[126:127], v[126:127], v[250:251] op_sel_hi:[1,0]
    v_pk_mul_f32 v[132:133], v[132:133], v[250:251] op_sel_hi:[1,0]
    v_pk_mul_f32 v[134:135], v[134:135], v[250:251] op_sel_hi:[1,0]
    v_pk_mul_f32 v[140:141], v[140:141], v[250:251] op_sel_hi:[1,0]
    v_pk_mul_f32 v[142:143], v[142:143], v[250:251] op_sel_hi:[1,0]
    v_pk_mul_f32 v[148:149], v[148:149], v[250:251] op_sel_hi:[1,0]
    v_pk_mul_f32 v[150:151], v[150:151], v[250:251] op_sel_hi:[1,0]
    v_pk_mul_f32 v[156:157], v[156:157], v[250:251] op_sel_hi:[1,0]
    v_pk_mul_f32 v[158:159], v[158:159], v[250:251] op_sel_hi:[1,0]
    v_mul_f32 v245, v245, v250
    v_exp_f32 v240, v176
    v_exp_f32 v241, v177
    v_exp_f32 v242, v178
    v_exp_f32 v243, v179
    v_add_f32 v246, v240, v241
    v_cvt_pk_bf16_f32 v88, v240, v241
    v_exp_f32 v240, v180
    v_exp_f32 v241, v181
    v_add_f32 v246, v246, v242
    v_cvt_pk_bf16_f32 v89, v242, v243
    v_add_f32 v246, v246, v243
    v_exp_f32 v242, v182
    v_exp_f32 v243, v183
    v_add_f32 v246, v246, v240
    v_cvt_pk_bf16_f32 v90, v240, v241
    v_add_f32 v246, v246, v241
    v_exp_f32 v240, v184
    v_exp_f32 v241, v185
    v_add_f32 v246, v246, v242
    v_cvt_pk_bf16_f32 v91, v242, v243
    v_add_f32 v246, v246, v243
    v_exp_f32 v242, v186
    v_exp_f32 v243, v187
    v_add_f32 v247, v240, v241
    v_cvt_pk_bf16_f32 v92, v240, v241
    v_exp_f32 v240, v188
    v_exp_f32 v241, v189
    v_add_f32 v247, v247, v242
    v_cvt_pk_bf16_f32 v93, v242, v243
    v_add_f32 v247, v247, v243
    v_exp_f32 v242, v190
    v_exp_f32 v243, v191
    v_add_f32 v247, v247, v240
    v_cvt_pk_bf16_f32 v94, v240, v241
    v_add_f32 v247, v247, v241
    v_add_f32 v247, v247, v242
    v_cvt_pk_bf16_f32 v95, v242, v243
    v_add_f32 v247, v247, v243
    s_nop 1
    s_branch RET1_E2
SLOW0_B1:
    s_nop 15
    v_max3_f32 v248, v160, v161, v162
    v_max3_f32 v248, v248, v163, v164
    v_max3_f32 v248, v248, v165, v166
    v_max3_f32 v248, v248, v167, 0
    v_mov_b32 v250, v248
    s_nop 1
    v_permlane16_swap_b32 v248, v250
    v_max_f32 v248, v248, v250
    s_nop 1
    v_mov_b32 v250, v248
    s_nop 1
    v_permlane32_swap_b32 v248, v250
    v_max_f32 v248, v248, v250
    v_exp_f32 v250, -v248
    v_sub_f32 v160, v160, v248
    v_sub_f32 v176, v176, v248
    v_sub_f32 v161, v161, v248
    v_sub_f32 v177, v177, v248
    v_sub_f32 v162, v162, v248
    v_sub_f32 v178, v178, v248
    v_sub_f32 v163, v163, v248
    v_sub_f32 v179, v179, v248
    v_sub_f32 v164, v164, v248
    v_sub_f32 v180, v180, v248
    v_sub_f32 v165, v165, v248
    v_sub_f32 v181, v181, v248
    v_sub_f32 v166, v166, v248
    v_sub_f32 v182, v182, v248
    v_sub_f32 v167, v167, v248
    v_sub_f32 v183, v183, v248
    v_sub_f32 v192, v192, v248
    v_sub_f32 v193, v193, v248
    v_sub_f32 v194, v194, v248
    v_sub_f32 v195, v195, v248
    v_pk_mul_f32 v[96:97], v[96:97], v[250:251] op_sel_hi:[1,0]
    v_pk_mul_f32 v[98:99], v[98:99], v[250:251] op_sel_hi:[1,0]
    v_pk_mul_f32 v[104:105], v[104:105], v[250:251] op_sel_hi:[1,0]
    v_pk_mul_f32 v[106:107], v[106:107], v[250:251] op_sel_hi:[1,0]
    v_pk_mul_f32 v[112:113], v[112:113], v[250:251] op_sel_hi:[1,0]
    v_pk_mul_f32 v[114:115], v[114:115], v[250:251] op_sel_hi:[1,0]
    v_pk_mul_f32 v[120:121], v[120:121], v[250:251] op_sel_hi:[1,0]
    v_pk_mul_f32 v[122:123], v[122:123], v[250:251] op_sel_hi:[1,0]
    v_pk_mul_f32 v[128:129], v[128:129], v[250:251] op_sel_hi:[1,0]
    v_pk_mul_f32 v[130:131], v[130:131], v[250:251] op_sel_hi:[1,0]
    v_pk_mul_f32 v[136:137], v[136:137], v[250:251] op_sel_hi:[1,0]
    v_pk_mul_f32 v[138:139], v[138:139], v[250:251] op_sel_hi:[1,0]
    v_pk_mul_f32 v[144:145], v[144:145], v[250:251] op_sel_hi:[1,0]
    v_pk_mul_f32 v[146:147], v[146:147], v[250:251] op_sel_hi:[1,0]
    v_pk_mul_f32 v[152:153], v[152:153], v[250:251] op_sel_hi:[1,0]
    v_pk_mul_f32 v[154:155], v[154:155], v[250:251] op_sel_hi:[1,0]
    v_mul_f32 v244, v244, v250
    v_exp_f32 v240, v160
    v_exp_f32 v241, v161
    v_exp_f32 v242, v162
    v_exp_f32 v243, v163
    v_add_f32 v246, v240, v241
    v_cvt_pk_bf16_f32 v80, v240, v241
    v_exp_f32 v240, v164
    v_exp_f32 v241, v165
    v_add_f32 v246, v246, v242
    v_cvt_pk_bf16_f32 v81, v242, v243
    v_add_f32 v246, v246, v243
    v_exp_f32 v242, v166
    v_exp_f32 v243, v167
    v_add_f32 v246, v246, v240
    v_cvt_pk_bf16_f32 v82, v240, v241
    v_add_f32 v246, v246, v241
    v_add_f32 v246, v246, v242
    v_cvt_pk_bf16_f32 v83, v242, v243
    v_add_f32 v246, v246, v243
    s_nop 1
    s_branch RET0_B1
SLOW1_B1:
    s_nop 15
    v_max3_f32 v248, v176, v177, v178
    v_max3_f32 v248, v248, v179, v180
    v_max3_f32 v248, v248, v181, v182
    v_max3_f32 v248, v248, v183, 0
    v_mov_b32 v250, v248
    s_nop 1
    v_permlane16_swap_b32 v248, v250
    v_max_f32 v248, v248, v250
    s_nop 1
    v_mov_b32 v250, v248
    s_nop 1
    v_permlane32_swap_b32 v248, v250
    v_max_f32 v248, v248, v250
    v_exp_f32 v250, -v248
    v_sub_f32 v176, v176, v248
    v_sub_f32 v160, v160, v248
    v_sub_f32 v177, v177, v248
    v_sub_f32 v161, v161, v248
    v_sub_f32 v178, v178, v248
    v_sub_f32 v162, v162, v248
    v_sub_f32 v179, v179, v248
    v_sub_f32 v163, v163, v248
    v_sub_f32 v180, v180, v248
    v_sub_f32 v164, v164, v248
    v_sub_f32 v181, v181, v248
    v_sub_f32 v165, v165, v248
    v_sub_f32 v182, v182, v248
    v_sub_f32 v166, v166, v248
    v_sub_f32 v183, v183, v248
    v_sub_f32 v167, v167, v248
    v_sub_f32 v192, v192, v248
    v_sub_f32 v193, v193, v248
    v_sub_f32 v194, v194, v248
    v_sub_f32 v195, v195, v248
    v_pk_mul_f32 v[96:97], v[96:97], v[250:251] op_sel_hi:[1,0]
    v_pk_mul_f32 v[98:99], v[98:99], v[250:251] op_sel_hi:[1,0]
    v_pk_mul_f32 v[104:105], v[104:105], v[250:251] op_sel_hi:[1,0]
    v_pk_mul_f32 v[106:107], v[106:107], v[250:251] op_sel_hi:[1,0]
    v_pk_mul_f32 v[112:113], v[112:113], v[250:251] op_sel_hi:[1,0]
    v_pk_mul_f32 v[114:115], v[114:115], v[250:251] op_sel_hi:[1,0]
    v_pk_mul_f32 v[120:121], v[120:121], v[250:251] op_sel_hi:[1,0]
    v_pk_mul_f32 v[122:123], v[122:123], v[250:251] op_sel_hi:[1,0]
    v_pk_mul_f32 v[128:129], v[128:129], v[250:251] op_sel_hi:[1,0]
    v_pk_mul_f32 v[130:131], v[130:131], v[250:251] op_sel_hi:[1,0]
    v_pk_mul_f32 v[136:137], v[136:137], v[250:251] op_sel_hi:[1,0]
    v_pk_mul_f32 v[138:139], v[138:139], v[250:251] op_sel_hi:[1,0]
    v_pk_mul_f32 v[144:145], v[144:145], v[250:251] op_sel_hi:[1,0]
    v_pk_mul_f32 v[146:147], v[146:147], v[250:251] op_sel_hi:[1,0]
    v_pk_mul_f32 v[152:153], v[152:153], v[250:251] op_sel_hi:[1,0]
    v_pk_mul_f32 v[154:155], v[154:155], v[250:251] op_sel_hi:[1,0]
    v_mul_f32 v244, v244, v250
    v_exp_f32 v240, v176
    v_exp_f32 v241, v177
    v_exp_f32 v242, v178
    v_exp_f32 v243, v179
    v_add_f32 v246, v240, v241
    v_cvt_pk_bf16_f32 v88, v240, v241
    v_exp_f32 v240, v180
    v_exp_f32 v241, v181
    v_add_f32 v246, v246, v242
    v_cvt_pk_bf16_f32 v89, v242, v243
    v_add_f32 v246, v246, v243
    v_exp_f32 v242, v182
    v_exp_f32 v243, v183
    v_add_f32 v246, v246, v240
    v_cvt_pk_bf16_f32 v90, v240, v241
    v_add_f32 v246, v246, v241
    v_add_f32 v246, v246, v242
    v_cvt_pk_bf16_f32 v91, v242, v243
    v_add_f32 v246, v246, v243
    s_nop 1
    s_branch RET1_B1
SLOW1_E1:
    s_nop 15
    v_max3_f32 v248, v176, v177, v178
    v_max3_f32 v248, v248, v179, v180
    v_max3_f32 v248, v248, v181, v182
    v_max3_f32 v248, v248, v183, 0
    v_mov_b32 v250, v248
    s_nop 1
    v_permlane16_swap_b32 v248, v250
    v_max_f32 v248, v248, v250
    s_nop 1
    v_mov_b32 v250, v248
    s_nop 1
    v_permlane32_swap_b32 v248, v250
    v_max_f32 v248, v248, v250
    v_exp_f32 v250, -v248
    v_sub_f32 v176, v176, v248
    v_sub_f32 v160, v160, v248
    v_sub_f32 v177, v177, v248
    v_sub_f32 v161, v161, v248
    v_sub_f32 v178, v178, v248
    v_sub_f32 v162, v162, v248
    v_sub_f32 v179, v179, v248
    v_sub_f32 v163, v163, v248
    v_sub_f32 v180, v180, v248
    v_sub_f32 v164, v164, v248
    v_sub_f32 v181, v181, v248
    v_sub_f32 v165, v165, v248
    v_sub_f32 v182, v182, v248
    v_sub_f32 v166, v166, v248
    v_sub_f32 v183, v183, v248
    v_sub_f32 v167, v167, v248
    v_sub_f32 v192, v192, v248
    v_sub_f32 v193, v193, v248
    v_sub_f32 v194, v194, v248
    v_sub_f32 v195, v195, v248
    v_pk_mul_f32 v[96:97], v[96:97], v[250:251] op_sel_hi:[1,0]
    v_pk_mul_f32 v[98:99], v[98:99], v[250:251] op_sel_hi:[1,0]
    v_pk_mul_f32 v[104:105], v[104:105], v[250:251] op_sel_hi:[1,0]
    v_pk_mul_f32 v[106:107], v[106:107], v[250:251] op_sel_hi:[1,0]
    v_pk_mul_f32 v[112:113], v[112:113], v[250:251] op_sel_hi:[1,0]
    v_pk_mul_f32 v[114:115], v[114:115], v[250:251] op_sel_hi:[1,0]
    v_pk_mul_f32 v[120:121], v[120:121], v[250:251] op_sel_hi:[1,0]
    v_pk_mul_f32 v[122:123], v[122:123], v[250:251] op_sel_hi:[1,0]
    v_pk_mul_f32 v[128:129], v[128:129], v[250:251] op_sel_hi:[1,0]
    v_pk_mul_f32 v[130:131], v[130:131], v[250:251] op_sel_hi:[1,0]
    v_pk_mul_f32 v[136:137], v[136:137], v[250:251] op_sel_hi:[1,0]
    v_pk_mul_f32 v[138:139], v[138:139], v[250:251] op_sel_hi:[1,0]
    v_pk_mul_f32 v[144:145], v[144:145], v[250:251] op_sel_hi:[1,0]
    v_pk_mul_f32 v[146:147], v[146:147], v[250:251] op_sel_hi:[1,0]
    v_pk_mul_f32 v[152:153], v[152:153], v[250:251] op_sel_hi:[1,0]
    v_pk_mul_f32 v[154:155], v[154:155], v[250:251] op_sel_hi:[1,0]
    v_mul_f32 v244, v244, v250
    v_exp_f32 v240, v176
    v_exp_f32 v241, v177
    v_exp_f32 v242, v178
    v_exp_f32 v243, v179
    v_add_f32 v246, v240, v241
    v_cvt_pk_bf16_f32 v88, v240, v241
    v_exp_f32 v240, v180
    v_exp_f32 v241, v181
    v_add_f32 v246, v246, v242
    v_cvt_pk_bf16_f32 v89, v242, v243
    v_add_f32 v246, v246, v243
    v_exp_f32 v242, v182
    v_exp_f32 v243, v183
    v_add_f32 v246, v246, v240
    v_cvt_pk_bf16_f32 v90, v240, v241
    v_add_f32 v246, v246, v241
    v_add_f32 v246, v246, v242
    v_cvt_pk_bf16_f32 v91, v242, v243
    v_add_f32 v246, v246, v243
    s_nop 1
    s_branch RET1_E1
K1_FIN:
    v_xor_b32 v4, 32, v253
    v_mov_b32 v5, 0
    buffer_load_dwordx2 v[6:7], v5, s[96:99], 0 offen sc0 sc1
    s_mov_b32 s74, 0
    s_mov_b32 s72, 15
    s_barrier
    ds_read_b64_tr_b16 v[128:129], v253 offset:0
    ds_read_b64_tr_b16 v[130:131], v253 offset:512
    ds_read_b64_tr_b16 v[132:133], v4 offset:0
    ds_read_b64_tr_b16 v[134:135], v4 offset:512
    ds_read_b128 v[140:143], v252 offset:0
    ds_read_b128 v[144:147], v252 offset:512
    ds_read_b128 v[148:151], v252 offset:1024
    ds_read_b128 v[152:155], v252 offset:1536
    ds_read_b128 v[156:159], v252 offset:2048
    ds_read_b128 v[160:163], v252 offset:2560
    ds_read_b128 v[164:167], v252 offset:3072
    ds_read_b128 v[168:171], v252 offset:3584
    ds_read_b128 v[172:175], v252 offset:4096
    ds_read_b128 v[176:179], v252 offset:4608
    ds_read_b128 v[180:183], v252 offset:5120
    ds_read_b128 v[184:187], v252 offset:5632
    ds_read_b128 v[188:191], v252 offset:6144
    ds_read_b128 v[192:195], v252 offset:6656
    s_add_u32 s74, s74, 1
    s_cmp_eq_u32 s74, 6
    s_movk_i32 s92, 14336
    s_cselect_b32 s92, 4294895616, s92
    s_cselect_b32 s74, 0, s74
    v_add_u32 v252, s92, v252
    v_add_u32 v253, 8192, v253
    v_and_b32 v253, 65535, v253
    v_xor_b32 v4, 32, v253
    s_waitcnt lgkmcnt(12)
    v_mfma_f32_16x16x32_bf16 v[16:19], v[128:131], v[140:143], 0
    v_mfma_f32_16x16x32_bf16 v[20:23], v[132:135], v[140:143], 0
    v_mfma_f32_16x16x32_bf16 v[24:27], v[128:131], v[144:147], 0
    v_mfma_f32_16x16x32_bf16 v[28:31], v[132:135], v[144:147], 0
    s_waitcnt lgkmcnt(10)
    v_mfma_f32_16x16x32_bf16 v[32:35], v[128:131], v[148:151], 0
    s_waitcnt lgkmcnt(0)
    s_barrier
    ds_read_b64_tr_b16 v[8:9], v253 offset:0
    v_mfma_f32_16x16x32_bf16 v[36:39], v[132:135], v[148:151], 0
    ds_read_b64_tr_b16 v[10:11], v253 offset:512
    v_mfma_f32_16x16x32_bf16 v[40:43], v[128:131], v[152:155], 0
    ds_read_b64_tr_b16 v[12:13], v4 offset:0
    v_mfma_f32_16x16x32_bf16 v[44:47], v[132:135], v[152:155], 0
    ds_read_b64_tr_b16 v[14:15], v4 offset:512
    v_mfma_f32_16x16x32_bf16 v[48:51], v[128:131], v[156:159], 0
    ds_read_b128 v[196:199], v252 offset:0
    v_mfma_f32_16x16x32_bf16 v[52:55], v[132:135], v[156:159], 0
    ds_read_b128 v[200:203], v252 offset:512
    v_mfma_f32_16x16x32_bf16 v[56:59], v[128:131], v[160:163], 0
    ds_read_b128 v[204:207], v252 offset:1024
    v_mfma_f32_16x16x32_bf16 v[60:63], v[132:135], v[160:163], 0
    ds_read_b128 v[208:211], v252 offset:1536
    v_mfma_f32_16x16x32_bf16 v[64:67], v[128:131], v[164:167], 0
    ds_read_b128 v[212:215], v252 offset:2048
    v_mfma_f32_16x16x32_bf16 v[68:71], v[132:135], v[164:167], 0
    ds_read_b128 v[216:219], v252 offset:2560
    v_mfma_f32_16x16x32_bf16 v[72:75], v[128:131], v[168:171], 0
    ds_read_b128 v[220:223], v252 offset:3072
    v_mfma_f32_16x16x32_bf16 v[76:79], v[132:135], v[168:171], 0
    ds_read_b128 v[224:227], v252 offset:3584
    v_mfma_f32_16x16x32_bf16 v[80:83], v[128:131], v[172:175], 0
    ds_read_b128 v[228:231], v252 offset:4096
    v_mfma_f32_16x16x32_bf16 v[84:87], v[132:135], v[172:175], 0
    ds_read_b128 v[232:235], v252 offset:4608
    v_mfma_f32_16x16x32_bf16 v[88:91], v[128:131], v[176:179], 0
    ds_read_b128 v[236:239], v252 offset:5120
    v_mfma_f32_16x16x32_bf16 v[92:95], v[132:135], v[176:179], 0
    ds_read_b128 v[240:243], v252 offset:5632
    v_mfma_f32_16x16x32_bf16 v[96:99], v[128:131], v[180:183], 0
    ds_read_b128 v[244:247], v252 offset:6144
    v_mfma_f32_16x16x32_bf16 v[100:103], v[132:135], v[180:183], 0
    ds_read_b128 v[248:251], v252 offset:6656
    v_mfma_f32_16x16x32_bf16 v[104:107], v[128:131], v[184:187], 0
    s_add_u32 s74, s74, 1
    s_cmp_eq_u32 s74, 6
    v_mfma_f32_16x16x32_bf16 v[108:111], v[132:135], v[184:187], 0
    s_movk_i32 s92, 14336
    s_cselect_b32 s92, 4294895616, s92
    v_mfma_f32_16x16x32_bf16 v[112:115], v[128:131], v[188:191], 0
    s_cselect_b32 s74, 0, s74
    v_add_u32 v252, s92, v252
    v_mfma_f32_16x16x32_bf16 v[116:119], v[132:135], v[188:191], 0
    v_add_u32 v253, 8192, v253
    v_mfma_f32_16x16x32_bf16 v[120:123], v[128:131], v[192:195], 0
    v_and_b32 v253, 65535, v253
    v_mfma_f32_16x16x32_bf16 v[124:127], v[132:135], v[192:195], 0
    v_xor_b32 v4, 32, v253
OP_LOOP:
    s_waitcnt lgkmcnt(12)
    v_mfma_f32_16x16x32_bf16 v[16:19], v[8:11], v[196:199], v[16:19]
    v_mfma_f32_16x16x32_bf16 v[20:23], v[12:15], v[196:199], v[20:23]
    v_mfma_f32_16x16x32_bf16 v[24:27], v[8:11], v[200:203], v[24:27]
    v_mfma_f32_16x16x32_bf16 v[28:31], v[12:15], v[200:203], v[28:31]
    s_waitcnt lgkmcnt(10)
    v_mfma_f32_16x16x32_bf16 v[32:35], v[8:11], v[204:207], v[32:35]
    s_waitcnt lgkmcnt(0)
    s_barrier
    ds_read_b64_tr_b16 v[128:129], v253 offset:0
    v_mfma_f32_16x16x32_bf16 v[36:39], v[12:15], v[204:207], v[36:39]
    ds_read_b64_tr_b16 v[130:131], v253 offset:512
    v_mfma_f32_16x16x32_bf16 v[40:43], v[8:11], v[208:211], v[40:43]
    ds_read_b64_tr_b16 v[132:133], v4 offset:0
    v_mfma_f32_16x16x32_bf16 v[44:47], v[12:15], v[208:211], v[44:47]
    ds_read_b64_tr_b16 v[134:135], v4 offset:512
    v_mfma_f32_16x16x32_bf16 v[48:51], v[8:11], v[212:215], v[48:51]
    ds_read_b128 v[140:143], v252 offset:0
    v_mfma_f32_16x16x32_bf16 v[52:55], v[12:15], v[212:215], v[52:55]
    ds_read_b128 v[144:147], v252 offset:512
    v_mfma_f32_16x16x32_bf16 v[56:59], v[8:11], v[216:219], v[56:59]
    ds_read_b128 v[148:151], v252 offset:1024
    v_mfma_f32_16x16x32_bf16 v[60:63], v[12:15], v[216:219], v[60:63]
    ds_read_b128 v[152:155], v252 offset:1536
    v_mfma_f32_16x16x32_bf16 v[64:67], v[8:11], v[220:223], v[64:67]
    ds_read_b128 v[156:159], v252 offset:2048
    v_mfma_f32_16x16x32_bf16 v[68:71], v[12:15], v[220:223], v[68:71]
    ds_read_b128 v[160:163], v252 offset:2560
    v_mfma_f32_16x16x32_bf16 v[72:75], v[8:11], v[224:227], v[72:75]
    ds_read_b128 v[164:167], v252 offset:3072
    v_mfma_f32_16x16x32_bf16 v[76:79], v[12:15], v[224:227], v[76:79]
    ds_read_b128 v[168:171], v252 offset:3584
    v_mfma_f32_16x16x32_bf16 v[80:83], v[8:11], v[228:231], v[80:83]
    ds_read_b128 v[172:175], v252 offset:4096
    v_mfma_f32_16x16x32_bf16 v[84:87], v[12:15], v[228:231], v[84:87]
    ds_read_b128 v[176:179], v252 offset:4608
    v_mfma_f32_16x16x32_bf16 v[88:91], v[8:11], v[232:235], v[88:91]
    ds_read_b128 v[180:183], v252 offset:5120
    v_mfma_f32_16x16x32_bf16 v[92:95], v[12:15], v[232:235], v[92:95]
    ds_read_b128 v[184:187], v252 offset:5632
    v_mfma_f32_16x16x32_bf16 v[96:99], v[8:11], v[236:239], v[96:99]
    ds_read_b128 v[188:191], v252 offset:6144
    v_mfma_f32_16x16x32_bf16 v[100:103], v[12:15], v[236:239], v[100:103]
    ds_read_b128 v[192:195], v252 offset:6656
    v_mfma_f32_16x16x32_bf16 v[104:107], v[8:11], v[240:243], v[104:107]
    s_add_u32 s74, s74, 1
    s_cmp_eq_u32 s74, 6
    v_mfma_f32_16x16x32_bf16 v[108:111], v[12:15], v[240:243], v[108:111]
    s_movk_i32 s92, 14336
    s_cselect_b32 s92, 4294895616, s92
    v_mfma_f32_16x16x32_bf16 v[112:115], v[8:11], v[244:247], v[112:115]
    s_cselect_b32 s74, 0, s74
    v_add_u32 v252, s92, v252
    v_mfma_f32_16x16x32_bf16 v[116:119], v[12:15], v[244:247], v[116:119]
    v_add_u32 v253, 8192, v253
    v_mfma_f32_16x16x32_bf16 v[120:123], v[8:11], v[248:251], v[120:123]
    v_and_b32 v253, 65535, v253
    v_mfma_f32_16x16x32_bf16 v[124:127], v[12:15], v[248:251], v[124:127]
    v_xor_b32 v4, 32, v253
    s_waitcnt lgkmcnt(12)
    v_mfma_f32_16x16x32_bf16 v[16:19], v[128:131], v[140:143], v[16:19]
    v_mfma_f32_16x16x32_bf16 v[20:23], v[132:135], v[140:143], v[20:23]
    v_mfma_f32_16x16x32_bf16 v[24:27], v[128:131], v[144:147], v[24:27]
    v_mfma_f32_16x16x32_bf16 v[28:31], v[132:135], v[144:147], v[28:31]
    s_waitcnt lgkmcnt(10)
    v_mfma_f32_16x16x32_bf16 v[32:35], v[128:131], v[148:151], v[32:35]
    s_cmp_gt_u32 s72, 14
    s_cbranch_scc1 OP_NOW
    s_waitcnt vmcnt(0)
OP_NOW:
    s_waitcnt lgkmcnt(0)
    s_barrier
    ds_read_b64_tr_b16 v[8:9], v253 offset:0
    v_mfma_f32_16x16x32_bf16 v[36:39], v[132:135], v[148:151], v[36:39]
    ds_read_b64_tr_b16 v[10:11], v253 offset:512
    v_mfma_f32_16x16x32_bf16 v[40:43], v[128:131], v[152:155], v[40:43]
    ds_read_b64_tr_b16 v[12:13], v4 offset:0
    v_mfma_f32_16x16x32_bf16 v[44:47], v[132:135], v[152:155], v[44:47]
    ds_read_b64_tr_b16 v[14:15], v4 offset:512
    v_mfma_f32_16x16x32_bf16 v[48:51], v[128:131], v[156:159], v[48:51]
    ds_read_b128 v[196:199], v252 offset:0
    v_mfma_f32_16x16x32_bf16 v[52:55], v[132:135], v[156:159], v[52:55]
    ds_read_b128 v[200:203], v252 offset:512
    v_mfma_f32_16x16x32_bf16 v[56:59], v[128:131], v[160:163], v[56:59]
    ds_read_b128 v[204:207], v252 offset:1024
    v_mfma_f32_16x16x32_bf16 v[60:63], v[132:135], v[160:163], v[60:63]
    ds_read_b128 v[208:211], v252 offset:1536
    v_mfma_f32_16x16x32_bf16 v[64:67], v[128:131], v[164:167], v[64:67]
    ds_read_b128 v[212:215], v252 offset:2048
    v_mfma_f32_16x16x32_bf16 v[68:71], v[132:135], v[164:167], v[68:71]
    ds_read_b128 v[216:219], v252 offset:2560
    v_mfma_f32_16x16x32_bf16 v[72:75], v[128:131], v[168:171], v[72:75]
    ds_read_b128 v[220:223], v252 offset:3072
    v_mfma_f32_16x16x32_bf16 v[76:79], v[132:135], v[168:171], v[76:79]
    ds_read_b128 v[224:227], v252 offset:3584
    v_mfma_f32_16x16x32_bf16 v[80:83], v[128:131], v[172:175], v[80:83]
    ds_read_b128 v[228:231], v252 offset:4096
    v_mfma_f32_16x16x32_bf16 v[84:87], v[132:135], v[172:175], v[84:87]
    ds_read_b128 v[232:235], v252 offset:4608
    v_mfma_f32_16x16x32_bf16 v[88:91], v[128:131], v[176:179], v[88:91]
    ds_read_b128 v[236:239], v252 offset:5120
    v_mfma_f32_16x16x32_bf16 v[92:95], v[132:135], v[176:179], v[92:95]
    ds_read_b128 v[240:243], v252 offset:5632
    v_mfma_f32_16x16x32_bf16 v[96:99], v[128:131], v[180:183], v[96:99]
    ds_read_b128 v[244:247], v252 offset:6144
    v_mfma_f32_16x16x32_bf16 v[100:103], v[132:135], v[180:183], v[100:103]
    ds_read_b128 v[248:251], v252 offset:6656
    v_mfma_f32_16x16x32_bf16 v[104:107], v[128:131], v[184:187], v[104:107]
    s_add_u32 s74, s74, 1
    s_cmp_eq_u32 s74, 6
    v_mfma_f32_16x16x32_bf16 v[108:111], v[132:135], v[184:187], v[108:111]
    s_movk_i32 s92, 14336
    s_cselect_b32 s92, 4294895616, s92
    v_mfma_f32_16x16x32_bf16 v[112:115], v[128:131], v[188:191], v[112:115]
    s_cselect_b32 s74, 0, s74
    v_add_u32 v252, s92, v252
    v_mfma_f32_16x16x32_bf16 v[116:119], v[132:135], v[188:191], v[116:119]
    v_add_u32 v253, 8192, v253
    v_and_b32 v253, 65535, v253
    v_mfma_f32_16x16x32_bf16 v[120:123], v[128:131], v[192:195], v[120:123]
    v_xor_b32 v4, 32, v253
    s_sub_u32 s72, s72, 1
    v_mfma_f32_16x16x32_bf16 v[124:127], v[132:135], v[192:195], v[124:127]
    s_cmp_lg_u32 s72, 0
    s_cbranch_scc1 OP_LOOP
    v_lshlrev_b32 v2, 4, v1
    s_lshl_b32 s76, s3, 12
    s_lshl_b32 s77, s41, 14
    s_add_u32 s80, s76, s77
    s_lshl_b32 s81, s41, 16
    s_add_u32 s81, s81, s76
    s_waitcnt lgkmcnt(12)
    v_mfma_f32_16x16x32_bf16 v[16:19], v[8:11], v[196:199], v[16:19]
    v_mfma_f32_16x16x32_bf16 v[20:23], v[12:15], v[196:199], v[20:23]
    v_mfma_f32_16x16x32_bf16 v[24:27], v[8:11], v[200:203], v[24:27]
    v_mfma_f32_16x16x32_bf16 v[28:31], v[12:15], v[200:203], v[28:31]
    s_waitcnt lgkmcnt(10)
    v_mfma_f32_16x16x32_bf16 v[32:35], v[8:11], v[204:207], v[32:35]
    v_mfma_f32_16x16x32_bf16 v[36:39], v[12:15], v[204:207], v[36:39]
    v_mfma_f32_16x16x32_bf16 v[40:43], v[8:11], v[208:211], v[40:43]
    v_mfma_f32_16x16x32_bf16 v[44:47], v[12:15], v[208:211], v[44:47]
    s_waitcnt lgkmcnt(8)
    v_mfma_f32_16x16x32_bf16 v[48:51], v[8:11], v[212:215], v[48:51]
    v_mfma_f32_16x16x32_bf16 v[52:55], v[12:15], v[212:215], v[52:55]
    v_mfma_f32_16x16x32_bf16 v[56:59], v[8:11], v[216:219], v[56:59]
    v_mfma_f32_16x16x32_bf16 v[60:63], v[12:15], v[216:219], v[60:63]
    s_waitcnt lgkmcnt(6)
    v_mfma_f32_16x16x32_bf16 v[64:67], v[8:11], v[220:223], v[64:67]
    v_mfma_f32_16x16x32_bf16 v[68:71], v[12:15], v[220:223], v[68:71]
    v_mfma_f32_16x16x32_bf16 v[72:75], v[8:11], v[224:227], v[72:75]
    v_mfma_f32_16x16x32_bf16 v[76:79], v[12:15], v[224:227], v[76:79]
    s_waitcnt lgkmcnt(4)
    v_mfma_f32_16x16x32_bf16 v[80:83], v[8:11], v[228:231], v[80:83]
    v_mfma_f32_16x16x32_bf16 v[84:87], v[12:15], v[228:231], v[84:87]
    v_mfma_f32_16x16x32_bf16 v[88:91], v[8:11], v[232:235], v[88:91]
    v_mfma_f32_16x16x32_bf16 v[92:95], v[12:15], v[232:235], v[92:95]
    s_waitcnt lgkmcnt(2)
    v_mfma_f32_16x16x32_bf16 v[96:99], v[8:11], v[236:239], v[96:99]
    v_mfma_f32_16x16x32_bf16 v[100:103], v[12:15], v[236:239], v[100:103]
    v_mfma_f32_16x16x32_bf16 v[104:107], v[8:11], v[240:243], v[104:107]
    v_mfma_f32_16x16x32_bf16 v[108:111], v[12:15], v[240:243], v[108:111]
    s_waitcnt lgkmcnt(0)
    v_mfma_f32_16x16x32_bf16 v[112:115], v[8:11], v[244:247], v[112:115]
    v_mfma_f32_16x16x32_bf16 v[116:119], v[12:15], v[244:247], v[116:119]
    v_mfma_f32_16x16x32_bf16 v[120:123], v[8:11], v[248:251], v[120:123]
    v_mfma_f32_16x16x32_bf16 v[124:127], v[12:15], v[248:251], v[124:127]
    s_cmp_eq_u32 s41, 0
    s_cbranch_scc1 XS0
    s_add_u32 s76, s80, 0
    v_cvt_pk_bf16_f32 v128, v16, v17
    v_cvt_pk_bf16_f32 v129, v18, v19
    v_cvt_pk_bf16_f32 v130, v20, v21
    v_cvt_pk_bf16_f32 v131, v22, v23
    buffer_store_dwordx4 v[128:131], v2, s[48:51], s76 offen offset:0 sc0 sc1
    v_cvt_pk_bf16_f32 v132, v24, v25
    v_cvt_pk_bf16_f32 v133, v26, v27
    v_cvt_pk_bf16_f32 v134, v28, v29
    v_cvt_pk_bf16_f32 v135, v30, v31
    buffer_store_dwordx4 v[132:135], v2, s[48:51], s76 offen offset:1024 sc0 sc1
XS0:
    s_cmp_eq_u32 s41, 1
    s_cbranch_scc1 XS1
    s_add_u32 s76, s80, 65536
    v_cvt_pk_bf16_f32 v136, v32, v33
    v_cvt_pk_bf16_f32 v137, v34, v35
    v_cvt_pk_bf16_f32 v138, v36, v37
    v_cvt_pk_bf16_f32 v139, v38, v39
    buffer_store_dwordx4 v[136:139], v2, s[48:51], s76 offen offset:0 sc0 sc1
    v_cvt_pk_bf16_f32 v140, v40, v41
    v_cvt_pk_bf16_f32 v141, v42, v43
    v_cvt_pk_bf16_f32 v142, v44, v45
    v_cvt_pk_bf16_f32 v143, v46, v47
    buffer_store_dwordx4 v[140:143], v2, s[48:51], s76 offen offset:1024 sc0 sc1
XS1:
    s_cmp_eq_u32 s41, 2
    s_cbranch_scc1 XS2
    s_add_u32 s76, s80, 131072
    v_cvt_pk_bf16_f32 v144, v48, v49
    v_cvt_pk_bf16_f32 v145, v50, v51
    v_cvt_pk_bf16_f32 v146, v52, v53
    v_cvt_pk_bf16_f32 v147, v54, v55
    buffer_store_dwordx4 v[144:147], v2, s[48:51], s76 offen offset:0 sc0 sc1
    v_cvt_pk_bf16_f32 v148, v56, v57
    v_cvt_pk_bf16_f32 v149, v58, v59
    v_cvt_pk_bf16_f32 v150, v60, v61
    v_cvt_pk_bf16_f32 v151, v62, v63
    buffer_store_dwordx4 v[148:151], v2, s[48:51], s76 offen offset:1024 sc0 sc1
XS2:
    s_cmp_eq_u32 s41, 3
    s_cbranch_scc1 XS3
    s_add_u32 s76, s80, 196608
    v_cvt_pk_bf16_f32 v152, v64, v65
    v_cvt_pk_bf16_f32 v153, v66, v67
    v_cvt_pk_bf16_f32 v154, v68, v69
    v_cvt_pk_bf16_f32 v155, v70, v71
    buffer_store_dwordx4 v[152:155], v2, s[48:51], s76 offen offset:0 sc0 sc1
    v_cvt_pk_bf16_f32 v156, v72, v73
    v_cvt_pk_bf16_f32 v157, v74, v75
    v_cvt_pk_bf16_f32 v158, v76, v77
    v_cvt_pk_bf16_f32 v159, v78, v79
    buffer_store_dwordx4 v[156:159], v2, s[48:51], s76 offen offset:1024 sc0 sc1
XS3:
    s_cmp_eq_u32 s41, 0
    s_cbranch_scc1 XS4
    s_add_u32 s76, s80, 0
    v_cvt_pk_bf16_f32 v160, v80, v81
    v_cvt_pk_bf16_f32 v161, v82, v83
    v_cvt_pk_bf16_f32 v162, v84, v85
    v_cvt_pk_bf16_f32 v163, v86, v87
    buffer_store_dwordx4 v[160:163], v2, s[48:51], s76 offen offset:2048 sc0 sc1
    v_cvt_pk_bf16_f32 v164, v88, v89
    v_cvt_pk_bf16_f32 v165, v90, v91
    v_cvt_pk_bf16_f32 v166, v92, v93
    v_cvt_pk_bf16_f32 v167, v94, v95
    buffer_store_dwordx4 v[164:167], v2, s[48:51], s76 offen offset:3072 sc0 sc1
XS4:
    s_cmp_eq_u32 s41, 1
    s_cbranch_scc1 XS5
    s_add_u32 s76, s80, 65536
    v_cvt_pk_bf16_f32 v168, v96, v97
    v_cvt_pk_bf16_f32 v169, v98, v99
    v_cvt_pk_bf16_f32 v170, v100, v101
    v_cvt_pk_bf16_f32 v171, v102, v103
    buffer_store_dwordx4 v[168:171], v2, s[48:51], s76 offen offset:2048 sc0 sc1
    v_cvt_pk_bf16_f32 v172, v104, v105
    v_cvt_pk_bf16_f32 v173, v106, v107
    v_cvt_pk_bf16_f32 v174, v108, v109
    v_cvt_pk_bf16_f32 v175, v110, v111
    buffer_store_dwordx4 v[172:175], v2, s[48:51], s76 offen offset:3072 sc0 sc1
XS5:
    s_cmp_eq_u32 s41, 2
    s_cbranch_scc1 XS6
    s_add_u32 s76, s80, 131072
    v_cvt_pk_bf16_f32 v176, v112, v113
    v_cvt_pk_bf16_f32 v177, v114, v115
    v_cvt_pk_bf16_f32 v178, v116, v117
    v_cvt_pk_bf16_f32 v179, v118, v119
    buffer_store_dwordx4 v[176:179], v2, s[48:51], s76 offen offset:2048 sc0 sc1
    v_cvt_pk_bf16_f32 v180, v120, v121
    v_cvt_pk_bf16_f32 v181, v122, v123
    v_cvt_pk_bf16_f32 v182, v124, v125
    v_cvt_pk_bf16_f32 v183, v126, v127
    buffer_store_dwordx4 v[180:183], v2, s[48:51], s76 offen offset:3072 sc0 sc1
XS6:
    s_cmp_lg_u32 s41, 0
    s_cbranch_scc1 XO0
    v_mov_b32 v184, v16
    v_mov_b32 v185, v17
    v_mov_b32 v186, v18
    v_mov_b32 v187, v19
    v_mov_b32 v188, v20
    v_mov_b32 v189, v21
    v_mov_b32 v190, v22
    v_mov_b32 v191, v23
    v_mov_b32 v192, v24
    v_mov_b32 v193, v25
    v_mov_b32 v194, v26
    v_mov_b32 v195, v27
    v_mov_b32 v196, v28
    v_mov_b32 v197, v29
    v_mov_b32 v198, v30
    v_mov_b32 v199, v31
    v_mov_b32 v200, v80
    v_mov_b32 v201, v81
    v_mov_b32 v202, v82
    v_mov_b32 v203, v83
    v_mov_b32 v204, v84
    v_mov_b32 v205, v85
    v_mov_b32 v206, v86
    v_mov_b32 v207, v87
    v_mov_b32 v208, v88
    v_mov_b32 v209, v89
    v_mov_b32 v210, v90
    v_mov_b32 v211, v91
    v_mov_b32 v212, v92
    v_mov_b32 v213, v93
    v_mov_b32 v214, v94
    v_mov_b32 v215, v95
XO0:
    s_cmp_lg_u32 s41, 1
    s_cbranch_scc1 XO1
    v_mov_b32 v184, v32
    v_mov_b32 v185, v33
    v_mov_b32 v186, v34
    v_mov_b32 v187, v35
    v_mov_b32 v188, v36
    v_mov_b32 v189, v37
    v_mov_b32 v190, v38
    v_mov_b32 v191, v39
    v_mov_b32 v192, v40
    v_mov_b32 v193, v41
    v_mov_b32 v194, v42
    v_mov_b32 v195, v43
    v_mov_b32 v196, v44
    v_mov_b32 v197, v45
    v_mov_b32 v198, v46
    v_mov_b32 v199, v47
    v_mov_b32 v200, v96
    v_mov_b32 v201, v97
    v_mov_b32 v202, v98
    v_mov_b32 v203, v99
    v_mov_b32 v204, v100
    v_mov_b32 v205, v101
    v_mov_b32 v206, v102
    v_mov_b32 v207, v103
    v_mov_b32 v208, v104
    v_mov_b32 v209, v105
    v_mov_b32 v210, v106
    v_mov_b32 v211, v107
    v_mov_b32 v212, v108
    v_mov_b32 v213, v109
    v_mov_b32 v214, v110
    v_mov_b32 v215, v111
XO1:
    s_cmp_lg_u32 s41, 2
    s_cbranch_scc1 XO2
    v_mov_b32 v184, v48
    v_mov_b32 v185, v49
    v_mov_b32 v186, v50
    v_mov_b32 v187, v51
    v_mov_b32 v188, v52
    v_mov_b32 v189, v53
    v_mov_b32 v190, v54
    v_mov_b32 v191, v55
    v_mov_b32 v192, v56
    v_mov_b32 v193, v57
    v_mov_b32 v194, v58
    v_mov_b32 v195, v59
    v_mov_b32 v196, v60
    v_mov_b32 v197, v61
    v_mov_b32 v198, v62
    v_mov_b32 v199, v63
    v_mov_b32 v200, v112
    v_mov_b32 v201, v113
    v_mov_b32 v202, v114
    v_mov_b32 v203, v115
    v_mov_b32 v204, v116
    v_mov_b32 v205, v117
    v_mov_b32 v206, v118
    v_mov_b32 v207, v119
    v_mov_b32 v208, v120
    v_mov_b32 v209, v121
    v_mov_b32 v210, v122
    v_mov_b32 v211, v123
    v_mov_b32 v212, v124
    v_mov_b32 v213, v125
    v_mov_b32 v214, v126
    v_mov_b32 v215, v127
XO2:
    s_cmp_lg_u32 s41, 3
    s_cbranch_scc1 XO3
    v_mov_b32 v184, v64
    v_mov_b32 v185, v65
    v_mov_b32 v186, v66
    v_mov_b32 v187, v67
    v_mov_b32 v188, v68
    v_mov_b32 v189, v69
    v_mov_b32 v190, v70
    v_mov_b32 v191, v71
    v_mov_b32 v192, v72
    v_mov_b32 v193, v73
    v_mov_b32 v194, v74
    v_mov_b32 v195, v75
    v_mov_b32 v196, v76
    v_mov_b32 v197, v77
    v_mov_b32 v198, v78
    v_mov_b32 v199, v79
XO3:
    v_and_b32 v3, 3, v1
    v_lshlrev_b32 v3, 3, v3
    s_lshl_b32 s76, s3, 7
    s_lshl_b32 s77, s41, 3
    s_add_u32 s77, s77, s76
    s_lshl_b32 s90, 1, s41
    s_or_b32 s90, s90, 0xfffffff0
    s_mov_b32 s91, -1
    s_mov_b32 s72, 0x40000
    s_waitcnt vmcnt(0)
    s_mov_b64 exec, 1
    buffer_store_dwordx2 v[6:7], v5, s[52:55], s77 offen sc0 sc1
    s_mov_b64 exec, -1
XPOLL:
    buffer_load_dwordx2 v[8:9], v3, s[52:55], s76 offen sc0 sc1
    s_waitcnt vmcnt(0)
    v_cmp_eq_u64 vcc, v[8:9], v[6:7]
    s_or_b64 vcc, vcc, s[90:91]
    s_cmp_eq_u64 vcc, -1
    s_cbranch_scc1 XPOLLED
    s_sleep 2
    s_sub_u32 s72, s72, 1
    s_cbranch_scc0 XPOLL
XPOLLED:
    s_add_u32 s76, s41, 1
    s_and_b32 s76, s76, 3
    s_lshl_b32 s76, s76, 14
    s_add_u32 s84, s81, s76
    s_add_u32 s76, s41, 2
    s_and_b32 s76, s76, 3
    s_lshl_b32 s76, s76, 14
    s_add_u32 s85, s81, s76
    s_add_u32 s76, s41, 3
    s_and_b32 s76, s76, 3
    s_lshl_b32 s76, s76, 14
    s_add_u32 s86, s81, s76
    buffer_load_dwordx4 v[16:19], v2, s[48:51], s84 offen offset:0 sc1
    buffer_load_dwordx4 v[20:23], v2, s[48:51], s85 offen offset:0 sc1
    buffer_load_dwordx4 v[24:27], v2, s[48:51], s86 offen offset:0 sc1
    buffer_load_dwordx4 v[28:31], v2, s[48:51], s84 offen offset:1024 sc1
    buffer_load_dwordx4 v[32:35], v2, s[48:51], s85 offen offset:1024 sc1
    buffer_load_dwordx4 v[36:39], v2, s[48:51], s86 offen offset:1024 sc1
    s_cmp_eq_u32 s41, 3
    s_cbranch_scc1 XL3
    buffer_load_dwordx4 v[40:43], v2, s[48:51], s84 offen offset:2048 sc1
    buffer_load_dwordx4 v[44:47], v2, s[48:51], s85 offen offset:2048 sc1
    buffer_load_dwordx4 v[48:51], v2, s[48:51], s86 offen offset:2048 sc1
    buffer_load_dwordx4 v[52:55], v2, s[48:51], s84 offen offset:3072 sc1
    buffer_load_dwordx4 v[56:59], v2, s[48:51], s85 offen offset:3072 sc1
    buffer_load_dwordx4 v[60:63], v2, s[48:51], s86 offen offset:3072 sc1
XL3:
    v_and_b32 v3, 15, v1
    v_lshlrev_b32 v3, 12, v3
    v_lshrrev_b32 v8, 5, v1
    v_lshl_add_u32 v3, v8, 4, v3
    v_bfe_u32 v8, v1, 4, 1
    v_lshl_add_u32 v3, v8, 5, v3
    s_lshl_b32 s76, s41, 17
    s_lshl_b32 s77, s3, 6
    s_add_u32 s76, s76, s77
    v_mov_b32 v8, 0x00003f80
    v_mov_b32 v9, 0x3f800000
    s_waitcnt vmcnt(0)
    v_lshlrev_b32 v8, 16, v16
    v_and_b32 v9, 0xffff0000, v16
    v_add_f32 v184, v184, v8
    v_add_f32 v185, v185, v9
    v_lshlrev_b32 v8, 16, v17
    v_and_b32 v9, 0xffff0000, v17
    v_add_f32 v186, v186, v8
    v_add_f32 v187, v187, v9
    v_lshlrev_b32 v8, 16, v18
    v_and_b32 v9, 0xffff0000, v18
    v_add_f32 v188, v188, v8
    v_add_f32 v189, v189, v9
    v_lshlrev_b32 v8, 16, v19
    v_and_b32 v9, 0xffff0000, v19
    v_add_f32 v190, v190, v8
    v_add_f32 v191, v191, v9
    v_lshlrev_b32 v8, 16, v20
    v_and_b32 v9, 0xffff0000, v20
    v_add_f32 v184, v184, v8
    v_add_f32 v185, v185, v9
    v_lshlrev_b32 v8, 16, v21
    v_and_b32 v9, 0xffff0000, v21
    v_add_f32 v186, v186, v8
    v_add_f32 v187, v187, v9
    v_lshlrev_b32 v8, 16, v22
    v_and_b32 v9, 0xffff0000, v22
    v_add_f32 v188, v188, v8
    v_add_f32 v189, v189, v9
    v_lshlrev_b32 v8, 16, v23
    v_and_b32 v9, 0xffff0000, v23
    v_add_f32 v190, v190, v8
    v_add_f32 v191, v191, v9
    v_lshlrev_b32 v8, 16, v24
    v_and_b32 v9, 0xffff0000, v24
    v_add_f32 v184, v184, v8
    v_add_f32 v185, v185, v9
    v_lshlrev_b32 v8, 16, v25
    v_and_b32 v9, 0xffff0000, v25
    v_add_f32 v186, v186, v8
    v_add_f32 v187, v187, v9
    v_lshlrev_b32 v8, 16, v26
    v_and_b32 v9, 0xffff0000, v26
    v_add_f32 v188, v188, v8
    v_add_f32 v189, v189, v9
    v_lshlrev_b32 v8, 16, v27
    v_and_b32 v9, 0xffff0000, v27
    v_add_f32 v190, v190, v8
    v_add_f32 v191, v191, v9
    v_cvt_pk_bf16_f32 v128, v184, v185
    v_cvt_pk_bf16_f32 v129, v186, v187
    v_cvt_pk_bf16_f32 v130, v188, v189
    v_cvt_pk_bf16_f32 v131, v190, v191
    s_nop 1
    v_permlane16_swap_b32 v128, v130
    v_permlane16_swap_b32 v129, v131
    buffer_store_dwordx4 v[128:131], v3, s[68:71], s76 offen
    s_add_u32 s76, s76, 65536
    v_lshlrev_b32 v8, 16, v28
    v_and_b32 v9, 0xffff0000, v28
    v_add_f32 v192, v192, v8
    v_add_f32 v193, v193, v9
    v_lshlrev_b32 v8, 16, v29
    v_and_b32 v9, 0xffff0000, v29
    v_add_f32 v194, v194, v8
    v_add_f32 v195, v195, v9
    v_lshlrev_b32 v8, 16, v30
    v_and_b32 v9, 0xffff0000, v30
    v_add_f32 v196, v196, v8
    v_add_f32 v197, v197, v9
    v_lshlrev_b32 v8, 16, v31
    v_and_b32 v9, 0xffff0000, v31
    v_add_f32 v198, v198, v8
    v_add_f32 v199, v199, v9
    v_lshlrev_b32 v8, 16, v32
    v_and_b32 v9, 0xffff0000, v32
    v_add_f32 v192, v192, v8
    v_add_f32 v193, v193, v9
    v_lshlrev_b32 v8, 16, v33
    v_and_b32 v9, 0xffff0000, v33
    v_add_f32 v194, v194, v8
    v_add_f32 v195, v195, v9
    v_lshlrev_b32 v8, 16, v34
    v_and_b32 v9, 0xffff0000, v34
    v_add_f32 v196, v196, v8
    v_add_f32 v197, v197, v9
    v_lshlrev_b32 v8, 16, v35
    v_and_b32 v9, 0xffff0000, v35
    v_add_f32 v198, v198, v8
    v_add_f32 v199, v199, v9
    v_lshlrev_b32 v8, 16, v36
    v_and_b32 v9, 0xffff0000, v36
    v_add_f32 v192, v192, v8
    v_add_f32 v193, v193, v9
    v_lshlrev_b32 v8, 16, v37
    v_and_b32 v9, 0xffff0000, v37
    v_add_f32 v194, v194, v8
    v_add_f32 v195, v195, v9
    v_lshlrev_b32 v8, 16, v38
    v_and_b32 v9, 0xffff0000, v38
    v_add_f32 v196, v196, v8
    v_add_f32 v197, v197, v9
    v_lshlrev_b32 v8, 16, v39
    v_and_b32 v9, 0xffff0000, v39
    v_add_f32 v198, v198, v8
    v_add_f32 v199, v199, v9
    v_cvt_pk_bf16_f32 v132, v192, v193
    v_cvt_pk_bf16_f32 v133, v194, v195
    v_cvt_pk_bf16_f32 v134, v196, v197
    v_cvt_pk_bf16_f32 v135, v198, v199
    s_nop 1
    v_permlane16_swap_b32 v132, v134
    v_permlane16_swap_b32 v133, v135
    buffer_store_dwordx4 v[132:135], v3, s[68:71], s76 offen
    s_add_u32 s76, s76, 458752
    s_cmp_eq_u32 s41, 3
    s_cbranch_scc1 XE3
    v_lshlrev_b32 v8, 16, v40
    v_and_b32 v9, 0xffff0000, v40
    v_add_f32 v200, v200, v8
    v_add_f32 v201, v201, v9
    v_lshlrev_b32 v8, 16, v41
    v_and_b32 v9, 0xffff0000, v41
    v_add_f32 v202, v202, v8
    v_add_f32 v203, v203, v9
    v_lshlrev_b32 v8, 16, v42
    v_and_b32 v9, 0xffff0000, v42
    v_add_f32 v204, v204, v8
    v_add_f32 v205, v205, v9
    v_lshlrev_b32 v8, 16, v43
    v_and_b32 v9, 0xffff0000, v43
    v_add_f32 v206, v206, v8
    v_add_f32 v207, v207, v9
    v_lshlrev_b32 v8, 16, v44
    v_and_b32 v9, 0xffff0000, v44
    v_add_f32 v200, v200, v8
    v_add_f32 v201, v201, v9
    v_lshlrev_b32 v8, 16, v45
    v_and_b32 v9, 0xffff0000, v45
    v_add_f32 v202, v202, v8
    v_add_f32 v203, v203, v9
    v_lshlrev_b32 v8, 16, v46
    v_and_b32 v9, 0xffff0000, v46
    v_add_f32 v204, v204, v8
    v_add_f32 v205, v205, v9
    v_lshlrev_b32 v8, 16, v47
    v_and_b32 v9, 0xffff0000, v47
    v_add_f32 v206, v206, v8
    v_add_f32 v207, v207, v9
    v_lshlrev_b32 v8, 16, v48
    v_and_b32 v9, 0xffff0000, v48
    v_add_f32 v200, v200, v8
    v_add_f32 v201, v201, v9
    v_lshlrev_b32 v8, 16, v49
    v_and_b32 v9, 0xffff0000, v49
    v_add_f32 v202, v202, v8
    v_add_f32 v203, v203, v9
    v_lshlrev_b32 v8, 16, v50
    v_and_b32 v9, 0xffff0000, v50
    v_add_f32 v204, v204, v8
    v_add_f32 v205, v205, v9
    v_lshlrev_b32 v8, 16, v51
    v_and_b32 v9, 0xffff0000, v51
    v_add_f32 v206, v206, v8
    v_add_f32 v207, v207, v9
    v_cvt_pk_bf16_f32 v136, v200, v201
    v_cvt_pk_bf16_f32 v137, v202, v203
    v_cvt_pk_bf16_f32 v138, v204, v205
    v_cvt_pk_bf16_f32 v139, v206, v207
    s_nop 1
    v_permlane16_swap_b32 v136, v138
    v_permlane16_swap_b32 v137, v139
    buffer_store_dwordx4 v[136:139], v3, s[68:71], s76 offen
    s_add_u32 s76, s76, 65536
    v_lshlrev_b32 v8, 16, v52
    v_and_b32 v9, 0xffff0000, v52
    v_add_f32 v208, v208, v8
    v_add_f32 v209, v209, v9
    v_lshlrev_b32 v8, 16, v53
    v_and_b32 v9, 0xffff0000, v53
    v_add_f32 v210, v210, v8
    v_add_f32 v211, v211, v9
    v_lshlrev_b32 v8, 16, v54
    v_and_b32 v9, 0xffff0000, v54
    v_add_f32 v212, v212, v8
    v_add_f32 v213, v213, v9
    v_lshlrev_b32 v8, 16, v55
    v_and_b32 v9, 0xffff0000, v55
    v_add_f32 v214, v214, v8
    v_add_f32 v215, v215, v9
    v_lshlrev_b32 v8, 16, v56
    v_and_b32 v9, 0xffff0000, v56
    v_add_f32 v208, v208, v8
    v_add_f32 v209, v209, v9
    v_lshlrev_b32 v8, 16, v57
    v_and_b32 v9, 0xffff0000, v57
    v_add_f32 v210, v210, v8
    v_add_f32 v211, v211, v9
    v_lshlrev_b32 v8, 16, v58
    v_and_b32 v9, 0xffff0000, v58
    v_add_f32 v212, v212, v8
    v_add_f32 v213, v213, v9
    v_lshlrev_b32 v8, 16, v59
    v_and_b32 v9, 0xffff0000, v59
    v_add_f32 v214, v214, v8
    v_add_f32 v215, v215, v9
    v_lshlrev_b32 v8, 16, v60
    v_and_b32 v9, 0xffff0000, v60
    v_add_f32 v208, v208, v8
    v_add_f32 v209, v209, v9
    v_lshlrev_b32 v8, 16, v61
    v_and_b32 v9, 0xffff0000, v61
    v_add_f32 v210, v210, v8
    v_add_f32 v211, v211, v9
    v_lshlrev_b32 v8, 16, v62
    v_and_b32 v9, 0xffff0000, v62
    v_add_f32 v212, v212, v8
    v_add_f32 v213, v213, v9
    v_lshlrev_b32 v8, 16, v63
    v_and_b32 v9, 0xffff0000, v63
    v_add_f32 v214, v214, v8
    v_add_f32 v215, v215, v9
    v_cvt_pk_bf16_f32 v140, v208, v209
    v_cvt_pk_bf16_f32 v141, v210, v211
    v_cvt_pk_bf16_f32 v142, v212, v213
    v_cvt_pk_bf16_f32 v143, v214, v215
    s_nop 1
    v_permlane16_swap_b32 v140, v142
    v_permlane16_swap_b32 v141, v143
    buffer_store_dwordx4 v[140:143], v3, s[68:71], s76 offen
XE3:
    s_endpgm
K_DONE:
    s_endpgm
.section .rodata,"a"
.p2align 6
.amdhsa_kernel concat_heads__mha_block_cached__gqa_block_cached__near_ridge_kernel
  .amdhsa_next_free_vgpr 256
  .amdhsa_next_free_sgpr 100
  .amdhsa_accum_offset 256
  .amdhsa_group_segment_fixed_size 0
  .amdhsa_kernarg_size 104
  .amdhsa_user_sgpr_count 2
  .amdhsa_user_sgpr_kernarg_segment_ptr 1
  .amdhsa_system_sgpr_workgroup_id_x 1
  .amdhsa_float_denorm_mode_32 3
.end_amdhsa_kernel
```
